```python
import torch

def _softmax(x, axis=-1):
    return torch.softmax(x, dim=axis)
def _gelu(x):
    return torch.nn.functional.gelu(x, approximate="tanh")
def _silu(x):
    return torch.nn.functional.silu(x)
def _sigmoid(x):
    return torch.sigmoid(x)
def _layernorm(x, axis=-1, eps=1e-5):
    m = x.mean(dim=axis, keepdim=True)
    v = x.var(dim=axis, keepdim=True, unbiased=False)
    return (x - m) / torch.sqrt(v + eps)
def _scatter_add(tgt, idx, src, axis=0):
    return tgt.clone().index_add_(axis, idx, src)
def _segment_sum(src, seg, n):
    out = torch.zeros((n,) + src.shape[1:], dtype=src.dtype)
    return out.index_add_(0, seg, src)
def _pad(x, pw):
    flat = tuple(v for pair in reversed(pw) for v in pair)
    return torch.nn.functional.pad(x, flat)

kernel_name = 'gated_mix__sliding_local_dilated__mha_block__prompt'

def setup_inputs():

    _w = (lambda a: (lambda t: t.to(torch.bfloat16) if t.is_floating_point() else t)(torch.as_tensor(a)))
    def _A_setup():
        B, S, D = 1, 2048, 640
        return {
            "x": _w((lambda *s: torch.randn(*s, dtype=torch.bfloat16) * 0.05)(B, S, D)),
            "wqkv": _w((lambda *s: torch.randn(*s, dtype=torch.bfloat16) * 1.6)(D, 3 * D)),
            "wo": _w((lambda *s: torch.randn(*s, dtype=torch.bfloat16) * 0.05)(D, D)),
        }
    _A_in = _A_setup()

    def _B_setup():
        B, S, D, H = 1, 2048, 640, 32
        return {
            "x": _w((lambda *s: torch.randn(*s, dtype=torch.bfloat16) * 0.05)(B, S, D)),
            "wqkv": _w((lambda *s: torch.randn(*s, dtype=torch.bfloat16) * 1.6)(D, 3 * D)),
            "wo": _w((lambda *s: torch.randn(*s, dtype=torch.bfloat16) * 0.1)(D, D)),
        }
    _B_in = _B_setup()

    return {
        "A_x": _A_in["x"],
        "A_wqkv": _A_in["wqkv"],
        "A_wo": _A_in["wo"],
        "B_x": _B_in["x"],
        "B_wqkv": _B_in["wqkv"],
        "B_wo": _B_in["wo"],
        "gate_w": _w((lambda *s: torch.randn(*s, dtype=torch.bfloat16) * 0.05)(640) * 16.0),
    }

def reference(A_x, A_wqkv, A_wo, B_x, B_wqkv, B_wo, gate_w):
    def _A_ref(x, wqkv, wo):
        B, S, D = x.shape
        H = 32; Dh = D // H
        W, dil = 8, 2
        qkv = (lambda x, *d: x.permute(*d))((x @ wqkv).reshape(B, S, 3, H, Dh), 2, 0, 3, 1, 4)
        q, k, v = qkv[0], qkv[1], qkv[2]
        scale = Dh ** -0.5
        pos = torch.arange(S)
        off = torch.arange(W) * dil
        idx = pos[:, None] - off[None, :]
        mask = idx >= 0
        idx_c = torch.where(mask, idx, 0).reshape(-1)
        kg = k[:, :, idx_c, :].reshape(B, H, S, W, Dh)
        vg = v[:, :, idx_c, :].reshape(B, H, S, W, Dh)
        logits = torch.einsum("bhsd,bhswd->bhsw", q, kg) * scale
        logits = torch.where(mask[None, None, :, :], logits, -1e9)
        attn = _softmax(logits, axis=-1)
        o = torch.einsum("bhsw,bhswd->bhsd", attn, vg)
        return (lambda x, *d: x.permute(*d))(o, 0, 2, 1, 3).reshape(B, S, D) @ wo

    def _B_ref(x, wqkv, wo):
        B, S, D = x.shape
        H = 32
        Dh = D // H
        qkv = (lambda x, *d: x.permute(*d))((x @ wqkv).reshape(B, S, 3, H, Dh), 2, 0, 3, 1, 4)
        q, k, v = qkv[0], qkv[1], qkv[2]
        scores = torch.einsum("bhqd,bhkd->bhqk", q, k) * (Dh ** -0.5)
        p = _softmax(scores, axis=-1)
        o = torch.einsum("bhqk,bhkd->bhqd", p, v)
        return (lambda x, *d: x.permute(*d))(o, 0, 2, 1, 3).reshape(B, S, D) @ wo

    x = A_x
    g = _sigmoid((x * gate_w).sum(-1, keepdims=True))
    a = _A_ref(x, A_wqkv, A_wo)
    b = _B_ref(x, B_wqkv, B_wo)
    return g * a + (1 - g) * b
```

```asm
; @launch kernel=qkv_kernel grid=(256,1,1) block=(512,1,1) lds=133632
; @launch kernel=attn_kernel grid=(512,1,1) block=(512,1,1) lds=81920
.amdgcn_target "amdgcn-amd-amdhsa--gfx950"
.text
.globl qkv_kernel
.p2align 8
.type qkv_kernel,@function
qkv_kernel:
    s_cmp_ge_u32 s2, 256
    s_cbranch_scc1 K1_END
    s_load_dwordx4 s[4:7], s[0:1], 0
    s_load_dwordx2 s[8:9], s[0:1], 32
    s_load_dwordx2 s[10:11], s[0:1], 72
    s_load_dwordx2 s[54:55], s[0:1], 48

    s_getpc_b64 s[52:53]
CT_38:
    s_add_u32 s52, s52, K1_CT0-CT_38
    s_addc_u32 s53, s53, 0
    v_lshlrev_b32 v30, 7, v0
    v_min_u32 v30, attn_kernel-K1_CT0-4, v30
    global_load_dword v31, v30, s[52:53]
K1_CT0:
    v_lshrrev_b32 v2, 6, v0
    v_and_b32 v1, 63, v0
    s_and_b32 s12, s2, 7
    v_readfirstlane_b32 s19, v2
    s_cmp_ge_u32 s2, 240
    s_cbranch_scc1 K1_SIDE
    s_lshr_b32 s13, s2, 3
    s_mul_i32 s12, s12, 30
    s_add_u32 s12, s12, s13
    s_cmp_ge_u32 s12, 120
    s_cselect_b32 s14, 1, 0
    s_cselect_b32 s13, 120, 0
    s_sub_u32 s12, s12, s13
    s_and_b32 s15, s12, 7
    s_lshr_b32 s16, s12, 3
    v_and_b32 v3, 15, v1
    v_lshrrev_b32 v4, 4, v1

    s_cmp_ge_u32 s19, 4
    s_cselect_b32 s12, 1, 0
    s_lshr_b32 s12, s19, s12
    s_and_b32 s12, s12, 1
    s_lshl_b32 s17, s16, 1
    s_add_u32 s17, s17, s12
    s_cmp_ge_u32 s17, 15
    s_cselect_b32 s18, 1, 0
    s_cselect_b32 s13, 15, 0
    s_sub_u32 s17, s17, s13
    s_movk_i32 s60, 3840
    s_mov_b32 s62, 2621440
    s_movk_i32 s63, 128
    s_cmp_ge_u32 s19, 4
    s_cbranch_scc0 K1_COMPUTE

    v_lshrrev_b32 v5, 1, v4
    v_and_b32 v6, 1, v4
    v_lshlrev_b32 v5, 4, v5
    v_lshl_add_u32 v5, v6, 2, v5
    v_mul_u32_u24 v5, 3840, v5
    v_lshl_add_u32 v8, v3, 4, v5
    v_add_u32 v9, 2784, v8
    v_add_u32 v10, 5568, v8
    v_add_u32 v11, 8352, v8
    v_lshrrev_b32 v5, 3, v1
    v_and_b32 v6, 7, v1
    v_xor_b32 v6, v6, v5
    v_mul_u32_u24 v5, 2560, v5
    v_lshl_add_u32 v12, v6, 4, v5
    v_add_u32 v13, 19456, v12
    v_add_u32 v14, 38912, v12
    v_add_u32 v15, 58368, v12
    s_and_b32 s13, s19, 1
    s_mul_i32 s32, s13, 30720
    s_lshl_b32 s3, s17, 8
    s_add_u32 s32, s32, s3
    s_and_b32 s3, s19, 3
    s_mul_i32 s34, s3, 4224
    s_lshl_b32 s35, s3, 12
    s_add_u32 s35, s35, 84480
    s_lshl_b32 s13, s15, 2
    s_add_u32 s13, s13, s3
    s_mul_i32 s33, s13, 81920
    s_mul_i32 s13, s14, 1280
    s_add_u32 s33, s33, s13
    s_add_u32 s3, s15, s16
    s_and_b32 s3, s3, 3
    s_mov_b32 s38, 1750279184
    s_mov_b32 s39, 151
    s_cmp_eq_u32 s3, 1
    s_cselect_b32 s38, 2520994305, s38
    s_cselect_b32 s39, 135, s39
    s_cmp_eq_u32 s3, 2
    s_cselect_b32 s38, 1967534338, s38
    s_cselect_b32 s39, 152, s39
    s_cmp_eq_u32 s3, 3
    s_cselect_b32 s38, 1702109488, s38
    s_cselect_b32 s39, 152, s39
    s_cmp_eq_u32 s18, 0
    s_waitcnt lgkmcnt(0)
    s_cselect_b64 s[6:7], s[6:7], s[8:9]

    s_mov_b32 s20, s4
    s_mov_b32 s21, s5
    s_mov_b32 s22, 2621440
    s_mov_b32 s23, 0x00020000
    s_mov_b32 s24, s6
    s_mov_b32 s25, s7
    s_mov_b32 s26, 2457600
    s_mov_b32 s27, 0x00020000
    s_add_u32 m0, s35, 0
    s_bfe_u32 s37, s38, 262144
    s_lshl_b32 s37, s37, 7
    s_add_u32 s37, s37, s33
    buffer_load_dwordx4 v12, s[20:23], s37 offen offset:0 lds
    buffer_load_dwordx4 v13, s[20:23], s37 offen offset:1024 lds
    buffer_load_dwordx4 v14, s[20:23], s37 offen offset:2048 lds
    buffer_load_dwordx4 v15, s[20:23], s37 offen offset:3072 lds
    s_add_u32 m0, s34, 0
    s_bfe_u32 s36, s38, 262144
    s_mul_i32 s36, s36, 245760
    s_add_u32 s36, s36, s32
    buffer_load_dwordx4 v8, s[24:27], s36 offen offset:0 lds
    buffer_load_dwordx4 v9, s[24:27], s36 offen offset:1056 lds
    buffer_load_dwordx4 v10, s[24:27], s36 offen offset:2112 lds
    buffer_load_dwordx4 v11, s[24:27], s36 offen offset:3168 lds
    s_add_u32 m0, s34, 16896
    s_add_u32 s36, s36, 122880
    buffer_load_dwordx4 v8, s[24:27], s36 offen offset:0 lds
    buffer_load_dwordx4 v9, s[24:27], s36 offen offset:1056 lds
    buffer_load_dwordx4 v10, s[24:27], s36 offen offset:2112 lds
    buffer_load_dwordx4 v11, s[24:27], s36 offen offset:3168 lds
    s_waitcnt vmcnt(4)
    s_barrier
    s_add_u32 m0, s35, 16384
    s_bfe_u32 s37, s38, 262148
    s_lshl_b32 s37, s37, 7
    s_add_u32 s37, s37, s33
    buffer_load_dwordx4 v12, s[20:23], s37 offen offset:0 lds
    buffer_load_dwordx4 v13, s[20:23], s37 offen offset:1024 lds
    buffer_load_dwordx4 v14, s[20:23], s37 offen offset:2048 lds
    buffer_load_dwordx4 v15, s[20:23], s37 offen offset:3072 lds
    s_add_u32 m0, s34, 33792
    s_bfe_u32 s36, s38, 262148
    s_mul_i32 s36, s36, 245760
    s_add_u32 s36, s36, s32
    buffer_load_dwordx4 v8, s[24:27], s36 offen offset:0 lds
    buffer_load_dwordx4 v9, s[24:27], s36 offen offset:1056 lds
    buffer_load_dwordx4 v10, s[24:27], s36 offen offset:2112 lds
    buffer_load_dwordx4 v11, s[24:27], s36 offen offset:3168 lds
    s_waitcnt vmcnt(8)
    s_barrier
    s_add_u32 m0, s34, 50688
    s_add_u32 s36, s36, 122880
    buffer_load_dwordx4 v8, s[24:27], s36 offen offset:0 lds
    buffer_load_dwordx4 v9, s[24:27], s36 offen offset:1056 lds
    buffer_load_dwordx4 v10, s[24:27], s36 offen offset:2112 lds
    buffer_load_dwordx4 v11, s[24:27], s36 offen offset:3168 lds
    s_add_u32 m0, s35, 32768
    s_bfe_u32 s37, s38, 262152
    s_lshl_b32 s37, s37, 7
    s_add_u32 s37, s37, s33
    buffer_load_dwordx4 v12, s[20:23], s37 offen offset:0 lds
    buffer_load_dwordx4 v13, s[20:23], s37 offen offset:1024 lds
    buffer_load_dwordx4 v14, s[20:23], s37 offen offset:2048 lds
    buffer_load_dwordx4 v15, s[20:23], s37 offen offset:3072 lds
    s_waitcnt vmcnt(8)
    s_barrier
    s_add_u32 m0, s34, 67584
    s_bfe_u32 s36, s38, 262152
    s_mul_i32 s36, s36, 245760
    s_add_u32 s36, s36, s32
    buffer_load_dwordx4 v8, s[24:27], s36 offen offset:0 lds
    buffer_load_dwordx4 v9, s[24:27], s36 offen offset:1056 lds
    buffer_load_dwordx4 v10, s[24:27], s36 offen offset:2112 lds
    buffer_load_dwordx4 v11, s[24:27], s36 offen offset:3168 lds
    s_add_u32 m0, s34, 0
    s_add_u32 s36, s36, 122880
    buffer_load_dwordx4 v8, s[24:27], s36 offen offset:0 lds
    buffer_load_dwordx4 v9, s[24:27], s36 offen offset:1056 lds
    buffer_load_dwordx4 v10, s[24:27], s36 offen offset:2112 lds
    buffer_load_dwordx4 v11, s[24:27], s36 offen offset:3168 lds
    s_waitcnt vmcnt(12)
    s_barrier
    s_add_u32 m0, s35, 0
    s_bfe_u32 s37, s38, 262156
    s_lshl_b32 s37, s37, 7
    s_add_u32 s37, s37, s33
    buffer_load_dwordx4 v12, s[20:23], s37 offen offset:0 lds
    buffer_load_dwordx4 v13, s[20:23], s37 offen offset:1024 lds
    buffer_load_dwordx4 v14, s[20:23], s37 offen offset:2048 lds
    buffer_load_dwordx4 v15, s[20:23], s37 offen offset:3072 lds
    s_add_u32 m0, s34, 16896
    s_bfe_u32 s36, s38, 262156
    s_mul_i32 s36, s36, 245760
    s_add_u32 s36, s36, s32
    buffer_load_dwordx4 v8, s[24:27], s36 offen offset:0 lds
    buffer_load_dwordx4 v9, s[24:27], s36 offen offset:1056 lds
    buffer_load_dwordx4 v10, s[24:27], s36 offen offset:2112 lds
    buffer_load_dwordx4 v11, s[24:27], s36 offen offset:3168 lds
    s_waitcnt vmcnt(12)
    s_barrier
    s_add_u32 m0, s34, 33792
    s_add_u32 s36, s36, 122880
    buffer_load_dwordx4 v8, s[24:27], s36 offen offset:0 lds
    buffer_load_dwordx4 v9, s[24:27], s36 offen offset:1056 lds
    buffer_load_dwordx4 v10, s[24:27], s36 offen offset:2112 lds
    buffer_load_dwordx4 v11, s[24:27], s36 offen offset:3168 lds
    s_add_u32 m0, s35, 16384
    s_bfe_u32 s37, s38, 262160
    s_lshl_b32 s37, s37, 7
    s_add_u32 s37, s37, s33
    buffer_load_dwordx4 v12, s[20:23], s37 offen offset:0 lds
    buffer_load_dwordx4 v13, s[20:23], s37 offen offset:1024 lds
    buffer_load_dwordx4 v14, s[20:23], s37 offen offset:2048 lds
    buffer_load_dwordx4 v15, s[20:23], s37 offen offset:3072 lds
    s_waitcnt vmcnt(16)
    s_barrier
    s_add_u32 m0, s34, 50688
    s_bfe_u32 s36, s38, 262160
    s_mul_i32 s36, s36, 245760
    s_add_u32 s36, s36, s32
    buffer_load_dwordx4 v8, s[24:27], s36 offen offset:0 lds
    buffer_load_dwordx4 v9, s[24:27], s36 offen offset:1056 lds
    buffer_load_dwordx4 v10, s[24:27], s36 offen offset:2112 lds
    buffer_load_dwordx4 v11, s[24:27], s36 offen offset:3168 lds
    s_add_u32 m0, s34, 67584
    s_add_u32 s36, s36, 122880
    buffer_load_dwordx4 v8, s[24:27], s36 offen offset:0 lds
    buffer_load_dwordx4 v9, s[24:27], s36 offen offset:1056 lds
    buffer_load_dwordx4 v10, s[24:27], s36 offen offset:2112 lds
    buffer_load_dwordx4 v11, s[24:27], s36 offen offset:3168 lds
    s_waitcnt vmcnt(16)
    s_barrier
    s_add_u32 m0, s35, 32768
    s_bfe_u32 s37, s38, 262164
    s_lshl_b32 s37, s37, 7
    s_add_u32 s37, s37, s33
    buffer_load_dwordx4 v12, s[20:23], s37 offen offset:0 lds
    buffer_load_dwordx4 v13, s[20:23], s37 offen offset:1024 lds
    buffer_load_dwordx4 v14, s[20:23], s37 offen offset:2048 lds
    buffer_load_dwordx4 v15, s[20:23], s37 offen offset:3072 lds
    s_add_u32 m0, s34, 0
    s_bfe_u32 s36, s38, 262164
    s_mul_i32 s36, s36, 245760
    s_add_u32 s36, s36, s32
    buffer_load_dwordx4 v8, s[24:27], s36 offen offset:0 lds
    buffer_load_dwordx4 v9, s[24:27], s36 offen offset:1056 lds
    buffer_load_dwordx4 v10, s[24:27], s36 offen offset:2112 lds
    buffer_load_dwordx4 v11, s[24:27], s36 offen offset:3168 lds
    s_waitcnt vmcnt(20)
    s_barrier
    s_add_u32 m0, s34, 16896
    s_add_u32 s36, s36, 122880
    buffer_load_dwordx4 v8, s[24:27], s36 offen offset:0 lds
    buffer_load_dwordx4 v9, s[24:27], s36 offen offset:1056 lds
    buffer_load_dwordx4 v10, s[24:27], s36 offen offset:2112 lds
    buffer_load_dwordx4 v11, s[24:27], s36 offen offset:3168 lds
    s_waitcnt vmcnt(16)
    s_barrier
    s_add_u32 m0, s35, 0
    s_bfe_u32 s37, s38, 262168
    s_lshl_b32 s37, s37, 7
    s_add_u32 s37, s37, s33
    buffer_load_dwordx4 v12, s[20:23], s37 offen offset:0 lds
    buffer_load_dwordx4 v13, s[20:23], s37 offen offset:1024 lds
    buffer_load_dwordx4 v14, s[20:23], s37 offen offset:2048 lds
    buffer_load_dwordx4 v15, s[20:23], s37 offen offset:3072 lds
    s_add_u32 m0, s34, 33792
    s_bfe_u32 s36, s38, 262168
    s_mul_i32 s36, s36, 245760
    s_add_u32 s36, s36, s32
    buffer_load_dwordx4 v8, s[24:27], s36 offen offset:0 lds
    buffer_load_dwordx4 v9, s[24:27], s36 offen offset:1056 lds
    buffer_load_dwordx4 v10, s[24:27], s36 offen offset:2112 lds
    buffer_load_dwordx4 v11, s[24:27], s36 offen offset:3168 lds
    s_waitcnt vmcnt(20)
    s_barrier
    s_add_u32 m0, s34, 50688
    s_add_u32 s36, s36, 122880
    buffer_load_dwordx4 v8, s[24:27], s36 offen offset:0 lds
    buffer_load_dwordx4 v9, s[24:27], s36 offen offset:1056 lds
    buffer_load_dwordx4 v10, s[24:27], s36 offen offset:2112 lds
    buffer_load_dwordx4 v11, s[24:27], s36 offen offset:3168 lds
    s_waitcnt vmcnt(16)
    s_barrier
    s_add_u32 m0, s35, 16384
    s_bfe_u32 s37, s38, 262172
    s_lshl_b32 s37, s37, 7
    s_add_u32 s37, s37, s33
    buffer_load_dwordx4 v12, s[20:23], s37 offen offset:0 lds
    buffer_load_dwordx4 v13, s[20:23], s37 offen offset:1024 lds
    buffer_load_dwordx4 v14, s[20:23], s37 offen offset:2048 lds
    buffer_load_dwordx4 v15, s[20:23], s37 offen offset:3072 lds
    s_add_u32 m0, s34, 67584
    s_bfe_u32 s36, s38, 262172
    s_mul_i32 s36, s36, 245760
    s_add_u32 s36, s36, s32
    buffer_load_dwordx4 v8, s[24:27], s36 offen offset:0 lds
    buffer_load_dwordx4 v9, s[24:27], s36 offen offset:1056 lds
    buffer_load_dwordx4 v10, s[24:27], s36 offen offset:2112 lds
    buffer_load_dwordx4 v11, s[24:27], s36 offen offset:3168 lds
    s_waitcnt vmcnt(20)
    s_barrier
    s_add_u32 m0, s34, 0
    s_add_u32 s36, s36, 122880
    buffer_load_dwordx4 v8, s[24:27], s36 offen offset:0 lds
    buffer_load_dwordx4 v9, s[24:27], s36 offen offset:1056 lds
    buffer_load_dwordx4 v10, s[24:27], s36 offen offset:2112 lds
    buffer_load_dwordx4 v11, s[24:27], s36 offen offset:3168 lds
    s_waitcnt vmcnt(16)
    s_barrier
    s_add_u32 m0, s35, 32768
    s_bfe_u32 s37, s39, 262144
    s_lshl_b32 s37, s37, 7
    s_add_u32 s37, s37, s33
    buffer_load_dwordx4 v12, s[20:23], s37 offen offset:0 lds
    buffer_load_dwordx4 v13, s[20:23], s37 offen offset:1024 lds
    buffer_load_dwordx4 v14, s[20:23], s37 offen offset:2048 lds
    buffer_load_dwordx4 v15, s[20:23], s37 offen offset:3072 lds
    s_add_u32 m0, s34, 16896
    s_bfe_u32 s36, s39, 262144
    s_mul_i32 s36, s36, 245760
    s_add_u32 s36, s36, s32
    buffer_load_dwordx4 v8, s[24:27], s36 offen offset:0 lds
    buffer_load_dwordx4 v9, s[24:27], s36 offen offset:1056 lds
    buffer_load_dwordx4 v10, s[24:27], s36 offen offset:2112 lds
    buffer_load_dwordx4 v11, s[24:27], s36 offen offset:3168 lds
    s_waitcnt vmcnt(20)
    s_barrier
    s_add_u32 m0, s34, 33792
    s_add_u32 s36, s36, 122880
    buffer_load_dwordx4 v8, s[24:27], s36 offen offset:0 lds
    buffer_load_dwordx4 v9, s[24:27], s36 offen offset:1056 lds
    buffer_load_dwordx4 v10, s[24:27], s36 offen offset:2112 lds
    buffer_load_dwordx4 v11, s[24:27], s36 offen offset:3168 lds
    s_waitcnt vmcnt(16)
    s_barrier
    s_add_u32 m0, s35, 0
    s_bfe_u32 s37, s39, 262148
    s_lshl_b32 s37, s37, 7
    s_add_u32 s37, s37, s33
    buffer_load_dwordx4 v12, s[20:23], s37 offen offset:0 lds
    buffer_load_dwordx4 v13, s[20:23], s37 offen offset:1024 lds
    buffer_load_dwordx4 v14, s[20:23], s37 offen offset:2048 lds
    buffer_load_dwordx4 v15, s[20:23], s37 offen offset:3072 lds
    s_add_u32 m0, s34, 50688
    s_bfe_u32 s36, s39, 262148
    s_mul_i32 s36, s36, 245760
    s_add_u32 s36, s36, s32
    buffer_load_dwordx4 v8, s[24:27], s36 offen offset:0 lds
    buffer_load_dwordx4 v9, s[24:27], s36 offen offset:1056 lds
    buffer_load_dwordx4 v10, s[24:27], s36 offen offset:2112 lds
    buffer_load_dwordx4 v11, s[24:27], s36 offen offset:3168 lds
    s_waitcnt vmcnt(20)
    s_barrier
    s_add_u32 m0, s34, 67584
    s_add_u32 s36, s36, 122880
    buffer_load_dwordx4 v8, s[24:27], s36 offen offset:0 lds
    buffer_load_dwordx4 v9, s[24:27], s36 offen offset:1056 lds
    buffer_load_dwordx4 v10, s[24:27], s36 offen offset:2112 lds
    buffer_load_dwordx4 v11, s[24:27], s36 offen offset:3168 lds
    s_waitcnt vmcnt(16)
    s_barrier
    s_waitcnt vmcnt(12)
    s_barrier
    s_waitcnt vmcnt(4)
    s_barrier
    s_waitcnt vmcnt(0)
    s_barrier
    s_barrier
    s_mov_b32 s28, s10
    s_mov_b32 s29, s11
    s_mov_b32 s30, 33554432
    s_mov_b32 s31, 0x00020000
    s_mov_b32 s56, s54
    s_mov_b32 s57, s55
    s_mov_b32 s58, 1280
    s_mov_b32 s59, 0x00020000
    s_lshl_b32 s3, s15, 7
    s_lshl_b32 s12, s16, 3
    s_add_u32 s3, s3, s12
    s_and_b32 s12, s19, 3
    s_lshl_b32 s12, s12, 1
    s_add_u32 s3, s3, s12
    s_mul_i32 s40, s3, 2560
    s_mul_i32 s12, s14, 1280
    s_add_u32 s40, s40, s12
    s_lshl_b32 s12, s14, 10
    s_add_u32 s3, s3, s12
    s_lshl_b32 s41, s3, 2
    s_add_u32 s41, s41, 29360128
    v_lshlrev_b32 v2, 2, v1
    v_mov_b32 v3, 0

    buffer_load_dword v32, v2, s[56:59], 0 offen offset:0
    buffer_load_dword v33, v2, s[56:59], 0 offen offset:256
    buffer_load_dword v34, v2, s[56:59], 0 offen offset:512
    buffer_load_dword v35, v2, s[56:59], 0 offen offset:768
    buffer_load_dword v36, v2, s[56:59], 0 offen offset:1024
    buffer_load_dword v40, v2, s[20:23], s40 offen offset:0
    buffer_load_dword v41, v2, s[20:23], s40 offen offset:256
    buffer_load_dword v42, v2, s[20:23], s40 offen offset:512
    buffer_load_dword v43, v2, s[20:23], s40 offen offset:768
    buffer_load_dword v44, v2, s[20:23], s40 offen offset:1024
    buffer_load_dword v45, v2, s[20:23], s40 offen offset:2560
    buffer_load_dword v46, v2, s[20:23], s40 offen offset:2816
    buffer_load_dword v47, v2, s[20:23], s40 offen offset:3072
    buffer_load_dword v48, v2, s[20:23], s40 offen offset:3328
    buffer_load_dword v49, v2, s[20:23], s40 offen offset:3584
    s_waitcnt vmcnt(0)
    v_dot2_f32_bf16 v52, v40, v32, 0
    v_dot2_f32_bf16 v53, v45, v32, 0
    v_dot2_f32_bf16 v52, v41, v33, v52
    v_dot2_f32_bf16 v53, v46, v33, v53
    v_dot2_f32_bf16 v52, v42, v34, v52
    v_dot2_f32_bf16 v53, v47, v34, v53
    v_dot2_f32_bf16 v52, v43, v35, v52
    v_dot2_f32_bf16 v53, v48, v35, v53
    v_dot2_f32_bf16 v52, v44, v36, v52
    v_dot2_f32_bf16 v53, v49, v36, v53
    s_nop 3
    v_add_f32_dpp v52, v52, v52 row_shr:1 row_mask:0xf bank_mask:0xf bound_ctrl:0
    v_add_f32_dpp v53, v53, v53 row_shr:1 row_mask:0xf bank_mask:0xf bound_ctrl:0
    s_nop 1
    v_add_f32_dpp v52, v52, v52 row_shr:2 row_mask:0xf bank_mask:0xf bound_ctrl:0
    v_add_f32_dpp v53, v53, v53 row_shr:2 row_mask:0xf bank_mask:0xf bound_ctrl:0
    s_nop 1
    v_add_f32_dpp v52, v52, v52 row_shr:4 row_mask:0xf bank_mask:0xf bound_ctrl:0
    v_add_f32_dpp v53, v53, v53 row_shr:4 row_mask:0xf bank_mask:0xf bound_ctrl:0
    s_nop 1
    v_add_f32_dpp v52, v52, v52 row_shr:8 row_mask:0xf bank_mask:0xf bound_ctrl:0
    v_add_f32_dpp v53, v53, v53 row_shr:8 row_mask:0xf bank_mask:0xf bound_ctrl:0
    s_nop 1
    v_add_f32_dpp v52, v52, v52 row_bcast:15 row_mask:0xa bank_mask:0xf
    v_add_f32_dpp v53, v53, v53 row_bcast:15 row_mask:0xa bank_mask:0xf
    s_nop 1
    v_add_f32_dpp v52, v52, v52 row_bcast:31 row_mask:0xc bank_mask:0xf
    v_add_f32_dpp v53, v53, v53 row_bcast:31 row_mask:0xc bank_mask:0xf
    s_nop 1
    v_mul_f32 v52, 0xbfb8aa3b, v52
    v_mul_f32 v53, 0xbfb8aa3b, v53
    v_exp_f32 v52, v52
    v_exp_f32 v53, v53
    s_nop 0
    v_add_f32 v52, 1.0, v52
    v_add_f32 v53, 1.0, v53
    v_rcp_f32 v52, v52
    v_rcp_f32 v53, v53
    s_mov_b32 exec_lo, 0
    s_mov_b32 exec_hi, 0x80000000
    buffer_store_dword v52, v3, s[28:31], s41 offen offset:0
    buffer_store_dword v53, v3, s[28:31], s41 offen offset:4
    s_mov_b64 exec, -1
    s_endpgm
K1_COMPUTE:
    v_and_b32 v5, 1, v4
    v_lshrrev_b32 v6, 2, v3
    v_lshl_add_u32 v5, v5, 2, v6
    v_mul_u32_u24 v5, 1056, v5
    v_lshrrev_b32 v6, 1, v4
    v_lshlrev_b32 v6, 9, v6
    v_and_b32 v7, 3, v3
    v_lshlrev_b32 v7, 3, v7
    v_add3_u32 v5, v5, v6, v7
    s_mul_i32 s3, s12, 8448
    v_add_u32 v8, s3, v5
    v_and_b32 v5, 3, v3
    v_bfe_u32 v6, v3, 2, 1
    v_lshl_or_b32 v5, v6, 3, v5
    v_bfe_u32 v6, v3, 3, 1
    v_lshl_or_b32 v5, v6, 2, v5
    v_and_b32 v6, 7, v5
    v_xor_b32 v6, v6, v4
    v_lshlrev_b32 v6, 4, v6
    v_lshl_add_u32 v5, v5, 7, v6
    s_lshr_b32 s13, s19, 1
    s_lshl_b32 s3, s13, 13
    s_add_u32 s3, s3, 84480
    v_add_u32 v10, s3, v5
    v_xor_b32 v11, 64, v10
    v_mov_b32 v12, v10
    v_mov_b32 v13, v11
    v_mov_b32 v9, v8
    s_mov_b32 s32, 16896
    s_mov_b32 s33, 16384
    s_mov_b32 s34, 0
    s_mul_i32 s35, s17, 52
    s_lshr_b32 s35, s35, 8
    s_mul_i32 s3, s35, 5
    s_sub_u32 s17, s17, s3
    s_mul_i32 s3, s18, 3
    s_add_u32 s3, s3, s35
    s_mul_i32 s36, s3, 2621440
    s_lshl_b32 s3, s14, 4
    s_lshl_b32 s16, s15, 1
    s_add_u32 s3, s3, s16
    s_add_u32 s3, s3, s13
    s_mul_i32 s3, s3, 81920
    s_add_u32 s36, s36, s3
    s_waitcnt lgkmcnt(0)

    s_mov_b32 s28, s10
    s_mov_b32 s29, s11
    s_mov_b32 s30, 33554432
    s_mov_b32 s31, 0x00020000
    v_mov_b32 v32, 0
    v_mov_b32 v33, 0
    v_mov_b32 v34, 0
    v_mov_b32 v35, 0
    v_mov_b32 v36, 0
    v_mov_b32 v37, 0
    v_mov_b32 v38, 0
    v_mov_b32 v39, 0
    v_mov_b32 v40, 0
    v_mov_b32 v41, 0
    v_mov_b32 v42, 0
    v_mov_b32 v43, 0
    v_mov_b32 v44, 0
    v_mov_b32 v45, 0
    v_mov_b32 v46, 0
    v_mov_b32 v47, 0
    v_mov_b32 v48, 0
    v_mov_b32 v49, 0
    v_mov_b32 v50, 0
    v_mov_b32 v51, 0
    v_mov_b32 v52, 0
    v_mov_b32 v53, 0
    v_mov_b32 v54, 0
    v_mov_b32 v55, 0
    v_mov_b32 v56, 0
    v_mov_b32 v57, 0
    v_mov_b32 v58, 0
    v_mov_b32 v59, 0
    v_mov_b32 v60, 0
    v_mov_b32 v61, 0
    v_mov_b32 v62, 0
    v_mov_b32 v63, 0
    v_mov_b32 v64, 0
    v_mov_b32 v65, 0
    v_mov_b32 v66, 0
    v_mov_b32 v67, 0
    v_mov_b32 v68, 0
    v_mov_b32 v69, 0
    v_mov_b32 v70, 0
    v_mov_b32 v71, 0
    v_mov_b32 v72, 0
    v_mov_b32 v73, 0
    v_mov_b32 v74, 0
    v_mov_b32 v75, 0
    v_mov_b32 v76, 0
    v_mov_b32 v77, 0
    v_mov_b32 v78, 0
    v_mov_b32 v79, 0
    v_mov_b32 v80, 0
    v_mov_b32 v81, 0
    v_mov_b32 v82, 0
    v_mov_b32 v83, 0
    v_mov_b32 v84, 0
    v_mov_b32 v85, 0
    v_mov_b32 v86, 0
    v_mov_b32 v87, 0
    v_mov_b32 v88, 0
    v_mov_b32 v89, 0
    v_mov_b32 v90, 0
    v_mov_b32 v91, 0
    v_mov_b32 v92, 0
    v_mov_b32 v93, 0
    v_mov_b32 v94, 0
    v_mov_b32 v95, 0
    v_mov_b32 v96, 0
    v_mov_b32 v97, 0
    v_mov_b32 v98, 0
    v_mov_b32 v99, 0
    v_mov_b32 v100, 0
    v_mov_b32 v101, 0
    v_mov_b32 v102, 0
    v_mov_b32 v103, 0
    v_mov_b32 v104, 0
    v_mov_b32 v105, 0
    v_mov_b32 v106, 0
    v_mov_b32 v107, 0
    v_mov_b32 v108, 0
    v_mov_b32 v109, 0
    v_mov_b32 v110, 0
    v_mov_b32 v111, 0
    v_mov_b32 v112, 0
    v_mov_b32 v113, 0
    v_mov_b32 v114, 0
    v_mov_b32 v115, 0
    v_mov_b32 v116, 0
    v_mov_b32 v117, 0
    v_mov_b32 v118, 0
    v_mov_b32 v119, 0
    v_mov_b32 v120, 0
    v_mov_b32 v121, 0
    v_mov_b32 v122, 0
    v_mov_b32 v123, 0
    v_mov_b32 v124, 0
    v_mov_b32 v125, 0
    v_mov_b32 v126, 0
    v_mov_b32 v127, 0
    v_mov_b32 v128, 0
    v_mov_b32 v129, 0
    v_mov_b32 v130, 0
    v_mov_b32 v131, 0
    v_mov_b32 v132, 0
    v_mov_b32 v133, 0
    v_mov_b32 v134, 0
    v_mov_b32 v135, 0
    v_mov_b32 v136, 0
    v_mov_b32 v137, 0
    v_mov_b32 v138, 0
    v_mov_b32 v139, 0
    v_mov_b32 v140, 0
    v_mov_b32 v141, 0
    v_mov_b32 v142, 0
    v_mov_b32 v143, 0
    v_mov_b32 v144, 0
    v_mov_b32 v145, 0
    v_mov_b32 v146, 0
    v_mov_b32 v147, 0
    v_mov_b32 v148, 0
    v_mov_b32 v149, 0
    v_mov_b32 v150, 0
    v_mov_b32 v151, 0
    v_mov_b32 v152, 0
    v_mov_b32 v153, 0
    v_mov_b32 v154, 0
    v_mov_b32 v155, 0
    v_mov_b32 v156, 0
    v_mov_b32 v157, 0
    v_mov_b32 v158, 0
    v_mov_b32 v159, 0
    s_cmp_eq_u32 s35, 2
    s_cbranch_scc1 K1_PRE_N
K1_PRE_T:
    s_barrier
    ds_read_b128 a[64:67], v12 offset:0
    ds_read_b128 a[68:71], v12 offset:2048
    ds_read_b128 a[72:75], v12 offset:4096
    ds_read_b128 a[76:79], v12 offset:6144
    ds_read_b64_tr_b16 a[0:1], v9 offset:0
    ds_read_b64_tr_b16 a[2:3], v9 offset:256
    ds_read_b64_tr_b16 a[4:5], v9 offset:32
    ds_read_b64_tr_b16 a[6:7], v9 offset:288
    ds_read_b64_tr_b16 a[8:9], v9 offset:64
    ds_read_b64_tr_b16 a[10:11], v9 offset:320
    ds_read_b64_tr_b16 a[12:13], v9 offset:96
    ds_read_b64_tr_b16 a[14:15], v9 offset:352
    ds_read_b64_tr_b16 a[16:17], v9 offset:128
    ds_read_b64_tr_b16 a[18:19], v9 offset:384
    ds_read_b64_tr_b16 a[20:21], v9 offset:160
    ds_read_b64_tr_b16 a[22:23], v9 offset:416
    ds_read_b64_tr_b16 a[24:25], v9 offset:192
    ds_read_b64_tr_b16 a[26:27], v9 offset:448
    ds_read_b64_tr_b16 a[28:29], v9 offset:224
    ds_read_b64_tr_b16 a[30:31], v9 offset:480
.p2align 3
K1_LOOP_T:
    v_add_u32 v9, s32, v8
    s_waitcnt lgkmcnt(0)
    s_barrier
    v_mfma_f32_16x16x32_bf16 v[32:35], a[0:3], a[64:67], v[32:35]
    ds_read_b128 a[80:83], v13 offset:0
    v_mfma_f32_16x16x32_bf16 v[36:39], a[0:3], a[68:71], v[36:39]
    ds_read_b128 a[84:87], v13 offset:2048
    v_mfma_f32_16x16x32_bf16 v[40:43], a[0:3], a[72:75], v[40:43]
    ds_read_b128 a[88:91], v13 offset:4096
    v_mfma_f32_16x16x32_bf16 v[44:47], a[0:3], a[76:79], v[44:47]
    ds_read_b128 a[92:95], v13 offset:6144
    v_mfma_f32_16x16x32_bf16 v[48:51], a[4:7], a[64:67], v[48:51]
    ds_read_b64_tr_b16 a[32:33], v9 offset:0
    v_mfma_f32_16x16x32_bf16 v[52:55], a[4:7], a[68:71], v[52:55]
    ds_read_b64_tr_b16 a[34:35], v9 offset:256
    v_mfma_f32_16x16x32_bf16 v[56:59], a[4:7], a[72:75], v[56:59]
    ds_read_b64_tr_b16 a[36:37], v9 offset:32
    v_mfma_f32_16x16x32_bf16 v[60:63], a[4:7], a[76:79], v[60:63]
    ds_read_b64_tr_b16 a[38:39], v9 offset:288
    v_mfma_f32_16x16x32_bf16 v[64:67], a[8:11], a[64:67], v[64:67]
    ds_read_b64_tr_b16 a[40:41], v9 offset:64
    v_mfma_f32_16x16x32_bf16 v[68:71], a[8:11], a[68:71], v[68:71]
    ds_read_b64_tr_b16 a[42:43], v9 offset:320
    v_mfma_f32_16x16x32_bf16 v[72:75], a[8:11], a[72:75], v[72:75]
    ds_read_b64_tr_b16 a[44:45], v9 offset:96
    v_mfma_f32_16x16x32_bf16 v[76:79], a[8:11], a[76:79], v[76:79]
    ds_read_b64_tr_b16 a[46:47], v9 offset:352
    v_mfma_f32_16x16x32_bf16 v[80:83], a[12:15], a[64:67], v[80:83]
    ds_read_b64_tr_b16 a[48:49], v9 offset:128
    v_mfma_f32_16x16x32_bf16 v[84:87], a[12:15], a[68:71], v[84:87]
    ds_read_b64_tr_b16 a[50:51], v9 offset:384
    v_mfma_f32_16x16x32_bf16 v[88:91], a[12:15], a[72:75], v[88:91]
    ds_read_b64_tr_b16 a[52:53], v9 offset:160
    v_mfma_f32_16x16x32_bf16 v[92:95], a[12:15], a[76:79], v[92:95]
    ds_read_b64_tr_b16 a[54:55], v9 offset:416
    v_mfma_f32_16x16x32_bf16 v[96:99], a[16:19], a[64:67], v[96:99]
    ds_read_b64_tr_b16 a[56:57], v9 offset:192
    v_mfma_f32_16x16x32_bf16 v[100:103], a[16:19], a[68:71], v[100:103]
    ds_read_b64_tr_b16 a[58:59], v9 offset:448
    v_mfma_f32_16x16x32_bf16 v[104:107], a[16:19], a[72:75], v[104:107]
    ds_read_b64_tr_b16 a[60:61], v9 offset:224
    v_mfma_f32_16x16x32_bf16 v[108:111], a[16:19], a[76:79], v[108:111]
    ds_read_b64_tr_b16 a[62:63], v9 offset:480
    v_mfma_f32_16x16x32_bf16 v[112:115], a[20:23], a[64:67], v[112:115]
    s_add_u32 s32, s32, 16896
    v_mfma_f32_16x16x32_bf16 v[116:119], a[20:23], a[68:71], v[116:119]
    s_cmp_ge_u32 s32, 84480
    v_mfma_f32_16x16x32_bf16 v[120:123], a[20:23], a[72:75], v[120:123]
    s_cselect_b32 s32, 0, s32
    v_mfma_f32_16x16x32_bf16 v[124:127], a[20:23], a[76:79], v[124:127]
    v_mfma_f32_16x16x32_bf16 v[128:131], a[24:27], a[64:67], v[128:131]
    v_mfma_f32_16x16x32_bf16 v[132:135], a[24:27], a[68:71], v[132:135]
    v_mfma_f32_16x16x32_bf16 v[136:139], a[24:27], a[72:75], v[136:139]
    v_mfma_f32_16x16x32_bf16 v[140:143], a[24:27], a[76:79], v[140:143]
    v_mfma_f32_16x16x32_bf16 v[144:147], a[28:31], a[64:67], v[144:147]
    v_mfma_f32_16x16x32_bf16 v[148:151], a[28:31], a[68:71], v[148:151]
    v_mfma_f32_16x16x32_bf16 v[152:155], a[28:31], a[72:75], v[152:155]
    v_mfma_f32_16x16x32_bf16 v[156:159], a[28:31], a[76:79], v[156:159]
    v_add_u32 v9, s32, v8
    v_add_u32 v12, s33, v10
    s_waitcnt lgkmcnt(0)
    s_barrier
    v_mfma_f32_16x16x32_bf16 v[32:35], a[32:35], a[80:83], v[32:35]
    ds_read_b128 a[64:67], v12 offset:0
    v_mfma_f32_16x16x32_bf16 v[36:39], a[32:35], a[84:87], v[36:39]
    ds_read_b128 a[68:71], v12 offset:2048
    v_mfma_f32_16x16x32_bf16 v[40:43], a[32:35], a[88:91], v[40:43]
    ds_read_b128 a[72:75], v12 offset:4096
    v_mfma_f32_16x16x32_bf16 v[44:47], a[32:35], a[92:95], v[44:47]
    ds_read_b128 a[76:79], v12 offset:6144
    v_mfma_f32_16x16x32_bf16 v[48:51], a[36:39], a[80:83], v[48:51]
    ds_read_b64_tr_b16 a[0:1], v9 offset:0
    v_mfma_f32_16x16x32_bf16 v[52:55], a[36:39], a[84:87], v[52:55]
    ds_read_b64_tr_b16 a[2:3], v9 offset:256
    v_mfma_f32_16x16x32_bf16 v[56:59], a[36:39], a[88:91], v[56:59]
    ds_read_b64_tr_b16 a[4:5], v9 offset:32
    v_mfma_f32_16x16x32_bf16 v[60:63], a[36:39], a[92:95], v[60:63]
    ds_read_b64_tr_b16 a[6:7], v9 offset:288
    v_mfma_f32_16x16x32_bf16 v[64:67], a[40:43], a[80:83], v[64:67]
    ds_read_b64_tr_b16 a[8:9], v9 offset:64
    v_mfma_f32_16x16x32_bf16 v[68:71], a[40:43], a[84:87], v[68:71]
    ds_read_b64_tr_b16 a[10:11], v9 offset:320
    v_mfma_f32_16x16x32_bf16 v[72:75], a[40:43], a[88:91], v[72:75]
    ds_read_b64_tr_b16 a[12:13], v9 offset:96
    v_mfma_f32_16x16x32_bf16 v[76:79], a[40:43], a[92:95], v[76:79]
    ds_read_b64_tr_b16 a[14:15], v9 offset:352
    v_mfma_f32_16x16x32_bf16 v[80:83], a[44:47], a[80:83], v[80:83]
    ds_read_b64_tr_b16 a[16:17], v9 offset:128
    v_mfma_f32_16x16x32_bf16 v[84:87], a[44:47], a[84:87], v[84:87]
    ds_read_b64_tr_b16 a[18:19], v9 offset:384
    v_mfma_f32_16x16x32_bf16 v[88:91], a[44:47], a[88:91], v[88:91]
    ds_read_b64_tr_b16 a[20:21], v9 offset:160
    v_mfma_f32_16x16x32_bf16 v[92:95], a[44:47], a[92:95], v[92:95]
    ds_read_b64_tr_b16 a[22:23], v9 offset:416
    v_mfma_f32_16x16x32_bf16 v[96:99], a[48:51], a[80:83], v[96:99]
    ds_read_b64_tr_b16 a[24:25], v9 offset:192
    v_mfma_f32_16x16x32_bf16 v[100:103], a[48:51], a[84:87], v[100:103]
    ds_read_b64_tr_b16 a[26:27], v9 offset:448
    v_mfma_f32_16x16x32_bf16 v[104:107], a[48:51], a[88:91], v[104:107]
    ds_read_b64_tr_b16 a[28:29], v9 offset:224
    v_mfma_f32_16x16x32_bf16 v[108:111], a[48:51], a[92:95], v[108:111]
    ds_read_b64_tr_b16 a[30:31], v9 offset:480
    v_mfma_f32_16x16x32_bf16 v[112:115], a[52:55], a[80:83], v[112:115]
    s_add_u32 s32, s32, 16896
    v_mfma_f32_16x16x32_bf16 v[116:119], a[52:55], a[84:87], v[116:119]
    s_cmp_ge_u32 s32, 84480
    v_mfma_f32_16x16x32_bf16 v[120:123], a[52:55], a[88:91], v[120:123]
    s_cselect_b32 s32, 0, s32
    v_mfma_f32_16x16x32_bf16 v[124:127], a[52:55], a[92:95], v[124:127]
    v_add_u32 v13, s33, v11
    v_mfma_f32_16x16x32_bf16 v[128:131], a[56:59], a[80:83], v[128:131]
    s_add_u32 s33, s33, 16384
    v_mfma_f32_16x16x32_bf16 v[132:135], a[56:59], a[84:87], v[132:135]
    s_cmp_ge_u32 s33, 49152
    v_mfma_f32_16x16x32_bf16 v[136:139], a[56:59], a[88:91], v[136:139]
    s_cselect_b32 s33, 0, s33
    v_mfma_f32_16x16x32_bf16 v[140:143], a[56:59], a[92:95], v[140:143]
    s_add_u32 s34, s34, 1
    v_mfma_f32_16x16x32_bf16 v[144:147], a[60:63], a[80:83], v[144:147]
    s_cmp_lt_u32 s34, 8
    v_mfma_f32_16x16x32_bf16 v[148:151], a[60:63], a[84:87], v[148:151]
    v_mfma_f32_16x16x32_bf16 v[152:155], a[60:63], a[88:91], v[152:155]
    v_mfma_f32_16x16x32_bf16 v[156:159], a[60:63], a[92:95], v[156:159]
    s_cbranch_scc1 K1_LOOP_T
    s_lshl_b32 s3, s17, 13
    s_add_u32 s36, s36, s3
    s_add_u32 s37, s36, 4096
    s_add_u32 s38, s36, 40960
    s_add_u32 s39, s37, 40960
    s_cmp_eq_u32 s35, 0
    s_cselect_b32 s40, 0x3ea52b5c, 1.0
    s_mov_b32 s41, s40
    v_lshlrev_b32 v14, 4, v1
    s_nop 3

    v_add_u32 v9, 50688, v8
    s_waitcnt lgkmcnt(0)
    s_barrier
    s_barrier
    s_barrier
    s_barrier
    ds_read_b64_tr_b16 a[0:1], v8 offset:16896
    ds_read_b64_tr_b16 a[2:3], v8 offset:17152
    ds_read_b64_tr_b16 a[4:5], v8 offset:33792
    ds_read_b64_tr_b16 a[6:7], v8 offset:34048
    ds_read_b64_tr_b16 a[8:9], v9 offset:0
    ds_read_b64_tr_b16 a[10:11], v9 offset:256
    ds_read_b64_tr_b16 a[12:13], v9 offset:16896
    ds_read_b64_tr_b16 a[14:15], v9 offset:17152
    ds_read_b128 a[80:83], v11 offset:32768
    ds_read_b128 a[84:87], v11 offset:34816
    ds_read_b128 a[88:91], v11 offset:36864
    ds_read_b128 a[92:95], v11 offset:38912
    ds_read_b128 a[32:35], v10 offset:0
    ds_read_b128 a[36:39], v10 offset:2048
    ds_read_b128 a[40:43], v10 offset:4096
    ds_read_b128 a[44:47], v10 offset:6144
    ds_read_b128 a[48:51], v11 offset:0
    ds_read_b128 a[52:55], v11 offset:2048
    ds_read_b128 a[56:59], v11 offset:4096
    ds_read_b128 a[60:63], v11 offset:6144
    s_waitcnt lgkmcnt(12)
    v_mfma_f32_16x16x32_bf16 v[32:35], a[0:3], a[64:67], v[32:35]
    ds_read_b64_tr_b16 a[16:17], v8 offset:16928
    ds_read_b64_tr_b16 a[18:19], v8 offset:17184
    v_mfma_f32_16x16x32_bf16 v[36:39], a[0:3], a[68:71], v[36:39]
    ds_read_b64_tr_b16 a[20:21], v8 offset:33824
    ds_read_b64_tr_b16 a[22:23], v8 offset:34080
    v_mfma_f32_16x16x32_bf16 v[40:43], a[0:3], a[72:75], v[40:43]
    ds_read_b64_tr_b16 a[24:25], v9 offset:32
    ds_read_b64_tr_b16 a[26:27], v9 offset:288
    v_mfma_f32_16x16x32_bf16 v[44:47], a[0:3], a[76:79], v[44:47]
    ds_read_b64_tr_b16 a[28:29], v9 offset:16928
    ds_read_b64_tr_b16 a[30:31], v9 offset:17184
    s_waitcnt lgkmcnt(15)
    v_mfma_f32_16x16x32_bf16 v[32:35], a[4:7], a[80:83], v[32:35]
    v_mfma_f32_16x16x32_bf16 v[36:39], a[4:7], a[84:87], v[36:39]
    v_mfma_f32_16x16x32_bf16 v[40:43], a[4:7], a[88:91], v[40:43]
    v_mfma_f32_16x16x32_bf16 v[44:47], a[4:7], a[92:95], v[44:47]
    s_waitcnt lgkmcnt(12)
    v_mfma_f32_16x16x32_bf16 v[32:35], a[8:11], a[32:35], v[32:35]
    v_mfma_f32_16x16x32_bf16 v[36:39], a[8:11], a[36:39], v[36:39]
    v_mfma_f32_16x16x32_bf16 v[40:43], a[8:11], a[40:43], v[40:43]
    v_mfma_f32_16x16x32_bf16 v[44:47], a[8:11], a[44:47], v[44:47]
    s_waitcnt lgkmcnt(8)
    v_mfma_f32_16x16x32_bf16 v[32:35], a[12:15], a[48:51], v[32:35]
    v_mfma_f32_16x16x32_bf16 v[36:39], a[12:15], a[52:55], v[36:39]
    v_mfma_f32_16x16x32_bf16 v[40:43], a[12:15], a[56:59], v[40:43]
    v_mfma_f32_16x16x32_bf16 v[44:47], a[12:15], a[60:63], v[44:47]
    s_waitcnt lgkmcnt(0)
    v_mfma_f32_16x16x32_bf16 v[48:51], a[16:19], a[64:67], v[48:51]
    ds_read_b64_tr_b16 a[0:1], v8 offset:16960
    ds_read_b64_tr_b16 a[2:3], v8 offset:17216
    v_mfma_f32_16x16x32_bf16 v[52:55], a[16:19], a[68:71], v[52:55]
    ds_read_b64_tr_b16 a[4:5], v8 offset:33856
    ds_read_b64_tr_b16 a[6:7], v8 offset:34112
    v_mfma_f32_16x16x32_bf16 v[56:59], a[16:19], a[72:75], v[56:59]
    ds_read_b64_tr_b16 a[8:9], v9 offset:64
    ds_read_b64_tr_b16 a[10:11], v9 offset:320
    v_mfma_f32_16x16x32_bf16 v[60:63], a[16:19], a[76:79], v[60:63]
    ds_read_b64_tr_b16 a[12:13], v9 offset:16960
    ds_read_b64_tr_b16 a[14:15], v9 offset:17216
    v_mfma_f32_16x16x32_bf16 v[48:51], a[20:23], a[80:83], v[48:51]
    v_pk_mul_f32 v[32:33], v[32:33], s[40:41]
    v_pk_mul_f32 v[34:35], v[34:35], s[40:41]
    v_mfma_f32_16x16x32_bf16 v[52:55], a[20:23], a[84:87], v[52:55]
    v_pk_mul_f32 v[36:37], v[36:37], s[40:41]
    v_pk_mul_f32 v[38:39], v[38:39], s[40:41]
    v_mfma_f32_16x16x32_bf16 v[56:59], a[20:23], a[88:91], v[56:59]
    v_cvt_pk_bf16_f32 v32, v32, v33
    v_cvt_pk_bf16_f32 v33, v34, v35
    v_mfma_f32_16x16x32_bf16 v[60:63], a[20:23], a[92:95], v[60:63]
    v_cvt_pk_bf16_f32 v34, v36, v37
    v_cvt_pk_bf16_f32 v35, v38, v39
    v_mfma_f32_16x16x32_bf16 v[48:51], a[24:27], a[32:35], v[48:51]
    s_nop 1
    v_permlane16_swap_b32 v32, v34
    v_mfma_f32_16x16x32_bf16 v[52:55], a[24:27], a[36:39], v[52:55]
    v_permlane16_swap_b32 v33, v35
    s_nop 0
    v_mfma_f32_16x16x32_bf16 v[56:59], a[24:27], a[40:43], v[56:59]
    buffer_store_dwordx4 v[32:35], v14, s[28:31], s36 offen offset:0 sc1
    v_pk_mul_f32 v[40:41], v[40:41], s[40:41]
    v_mfma_f32_16x16x32_bf16 v[60:63], a[24:27], a[44:47], v[60:63]
    v_pk_mul_f32 v[42:43], v[42:43], s[40:41]
    v_pk_mul_f32 v[44:45], v[44:45], s[40:41]
    v_mfma_f32_16x16x32_bf16 v[48:51], a[28:31], a[48:51], v[48:51]
    v_pk_mul_f32 v[46:47], v[46:47], s[40:41]
    v_cvt_pk_bf16_f32 v40, v40, v41
    v_mfma_f32_16x16x32_bf16 v[52:55], a[28:31], a[52:55], v[52:55]
    v_cvt_pk_bf16_f32 v41, v42, v43
    v_cvt_pk_bf16_f32 v42, v44, v45
    v_mfma_f32_16x16x32_bf16 v[56:59], a[28:31], a[56:59], v[56:59]
    v_cvt_pk_bf16_f32 v43, v46, v47
    s_nop 1
    v_mfma_f32_16x16x32_bf16 v[60:63], a[28:31], a[60:63], v[60:63]
    v_permlane16_swap_b32 v40, v42
    v_permlane16_swap_b32 v41, v43
    s_nop 0
    buffer_store_dwordx4 v[40:43], v14, s[28:31], s38 offen offset:0 sc1
    s_waitcnt lgkmcnt(0)
    v_mfma_f32_16x16x32_bf16 v[64:67], a[0:3], a[64:67], v[64:67]
    ds_read_b64_tr_b16 a[16:17], v8 offset:16992
    ds_read_b64_tr_b16 a[18:19], v8 offset:17248
    v_mfma_f32_16x16x32_bf16 v[68:71], a[0:3], a[68:71], v[68:71]
    ds_read_b64_tr_b16 a[20:21], v8 offset:33888
    ds_read_b64_tr_b16 a[22:23], v8 offset:34144
    v_mfma_f32_16x16x32_bf16 v[72:75], a[0:3], a[72:75], v[72:75]
    ds_read_b64_tr_b16 a[24:25], v9 offset:96
    ds_read_b64_tr_b16 a[26:27], v9 offset:352
    v_mfma_f32_16x16x32_bf16 v[76:79], a[0:3], a[76:79], v[76:79]
    ds_read_b64_tr_b16 a[28:29], v9 offset:16992
    ds_read_b64_tr_b16 a[30:31], v9 offset:17248
    v_mfma_f32_16x16x32_bf16 v[64:67], a[4:7], a[80:83], v[64:67]
    v_pk_mul_f32 v[48:49], v[48:49], s[40:41]
    v_pk_mul_f32 v[50:51], v[50:51], s[40:41]
    v_mfma_f32_16x16x32_bf16 v[68:71], a[4:7], a[84:87], v[68:71]
    v_pk_mul_f32 v[52:53], v[52:53], s[40:41]
    v_pk_mul_f32 v[54:55], v[54:55], s[40:41]
    v_mfma_f32_16x16x32_bf16 v[72:75], a[4:7], a[88:91], v[72:75]
    v_cvt_pk_bf16_f32 v48, v48, v49
    v_cvt_pk_bf16_f32 v49, v50, v51
    v_mfma_f32_16x16x32_bf16 v[76:79], a[4:7], a[92:95], v[76:79]
    v_cvt_pk_bf16_f32 v50, v52, v53
    v_cvt_pk_bf16_f32 v51, v54, v55
    v_mfma_f32_16x16x32_bf16 v[64:67], a[8:11], a[32:35], v[64:67]
    s_nop 1
    v_permlane16_swap_b32 v48, v50
    v_mfma_f32_16x16x32_bf16 v[68:71], a[8:11], a[36:39], v[68:71]
    v_permlane16_swap_b32 v49, v51
    s_nop 0
    v_mfma_f32_16x16x32_bf16 v[72:75], a[8:11], a[40:43], v[72:75]
    buffer_store_dwordx4 v[48:51], v14, s[28:31], s36 offen offset:1024 sc1
    v_pk_mul_f32 v[56:57], v[56:57], s[40:41]
    v_mfma_f32_16x16x32_bf16 v[76:79], a[8:11], a[44:47], v[76:79]
    v_pk_mul_f32 v[58:59], v[58:59], s[40:41]
    v_pk_mul_f32 v[60:61], v[60:61], s[40:41]
    v_mfma_f32_16x16x32_bf16 v[64:67], a[12:15], a[48:51], v[64:67]
    v_pk_mul_f32 v[62:63], v[62:63], s[40:41]
    v_cvt_pk_bf16_f32 v56, v56, v57
    v_mfma_f32_16x16x32_bf16 v[68:71], a[12:15], a[52:55], v[68:71]
    v_cvt_pk_bf16_f32 v57, v58, v59
    v_cvt_pk_bf16_f32 v58, v60, v61
    v_mfma_f32_16x16x32_bf16 v[72:75], a[12:15], a[56:59], v[72:75]
    v_cvt_pk_bf16_f32 v59, v62, v63
    s_nop 1
    v_mfma_f32_16x16x32_bf16 v[76:79], a[12:15], a[60:63], v[76:79]
    v_permlane16_swap_b32 v56, v58
    v_permlane16_swap_b32 v57, v59
    s_nop 0
    buffer_store_dwordx4 v[56:59], v14, s[28:31], s38 offen offset:1024 sc1
    s_waitcnt lgkmcnt(0)
    v_mfma_f32_16x16x32_bf16 v[80:83], a[16:19], a[64:67], v[80:83]
    ds_read_b64_tr_b16 a[0:1], v8 offset:17024
    ds_read_b64_tr_b16 a[2:3], v8 offset:17280
    v_mfma_f32_16x16x32_bf16 v[84:87], a[16:19], a[68:71], v[84:87]
    ds_read_b64_tr_b16 a[4:5], v8 offset:33920
    ds_read_b64_tr_b16 a[6:7], v8 offset:34176
    v_mfma_f32_16x16x32_bf16 v[88:91], a[16:19], a[72:75], v[88:91]
    ds_read_b64_tr_b16 a[8:9], v9 offset:128
    ds_read_b64_tr_b16 a[10:11], v9 offset:384
    v_mfma_f32_16x16x32_bf16 v[92:95], a[16:19], a[76:79], v[92:95]
    ds_read_b64_tr_b16 a[12:13], v9 offset:17024
    ds_read_b64_tr_b16 a[14:15], v9 offset:17280
    v_mfma_f32_16x16x32_bf16 v[80:83], a[20:23], a[80:83], v[80:83]
    v_pk_mul_f32 v[64:65], v[64:65], s[40:41]
    v_pk_mul_f32 v[66:67], v[66:67], s[40:41]
    v_mfma_f32_16x16x32_bf16 v[84:87], a[20:23], a[84:87], v[84:87]
    v_pk_mul_f32 v[68:69], v[68:69], s[40:41]
    v_pk_mul_f32 v[70:71], v[70:71], s[40:41]
    v_mfma_f32_16x16x32_bf16 v[88:91], a[20:23], a[88:91], v[88:91]
    v_cvt_pk_bf16_f32 v64, v64, v65
    v_cvt_pk_bf16_f32 v65, v66, v67
    v_mfma_f32_16x16x32_bf16 v[92:95], a[20:23], a[92:95], v[92:95]
    v_cvt_pk_bf16_f32 v66, v68, v69
    v_cvt_pk_bf16_f32 v67, v70, v71
    v_mfma_f32_16x16x32_bf16 v[80:83], a[24:27], a[32:35], v[80:83]
    s_nop 1
    v_permlane16_swap_b32 v64, v66
    v_mfma_f32_16x16x32_bf16 v[84:87], a[24:27], a[36:39], v[84:87]
    v_permlane16_swap_b32 v65, v67
    s_nop 0
    v_mfma_f32_16x16x32_bf16 v[88:91], a[24:27], a[40:43], v[88:91]
    buffer_store_dwordx4 v[64:67], v14, s[28:31], s36 offen offset:2048 sc1
    v_pk_mul_f32 v[72:73], v[72:73], s[40:41]
    v_mfma_f32_16x16x32_bf16 v[92:95], a[24:27], a[44:47], v[92:95]
    v_pk_mul_f32 v[74:75], v[74:75], s[40:41]
    v_pk_mul_f32 v[76:77], v[76:77], s[40:41]
    v_mfma_f32_16x16x32_bf16 v[80:83], a[28:31], a[48:51], v[80:83]
    v_pk_mul_f32 v[78:79], v[78:79], s[40:41]
    v_cvt_pk_bf16_f32 v72, v72, v73
    v_mfma_f32_16x16x32_bf16 v[84:87], a[28:31], a[52:55], v[84:87]
    v_cvt_pk_bf16_f32 v73, v74, v75
    v_cvt_pk_bf16_f32 v74, v76, v77
    v_mfma_f32_16x16x32_bf16 v[88:91], a[28:31], a[56:59], v[88:91]
    v_cvt_pk_bf16_f32 v75, v78, v79
    s_nop 1
    v_mfma_f32_16x16x32_bf16 v[92:95], a[28:31], a[60:63], v[92:95]
    v_permlane16_swap_b32 v72, v74
    v_permlane16_swap_b32 v73, v75
    s_nop 0
    buffer_store_dwordx4 v[72:75], v14, s[28:31], s38 offen offset:2048 sc1
    s_waitcnt lgkmcnt(0)
    v_mfma_f32_16x16x32_bf16 v[96:99], a[0:3], a[64:67], v[96:99]
    ds_read_b64_tr_b16 a[16:17], v8 offset:17056
    ds_read_b64_tr_b16 a[18:19], v8 offset:17312
    v_mfma_f32_16x16x32_bf16 v[100:103], a[0:3], a[68:71], v[100:103]
    ds_read_b64_tr_b16 a[20:21], v8 offset:33952
    ds_read_b64_tr_b16 a[22:23], v8 offset:34208
    v_mfma_f32_16x16x32_bf16 v[104:107], a[0:3], a[72:75], v[104:107]
    ds_read_b64_tr_b16 a[24:25], v9 offset:160
    ds_read_b64_tr_b16 a[26:27], v9 offset:416
    v_mfma_f32_16x16x32_bf16 v[108:111], a[0:3], a[76:79], v[108:111]
    ds_read_b64_tr_b16 a[28:29], v9 offset:17056
    ds_read_b64_tr_b16 a[30:31], v9 offset:17312
    v_mfma_f32_16x16x32_bf16 v[96:99], a[4:7], a[80:83], v[96:99]
    v_pk_mul_f32 v[80:81], v[80:81], s[40:41]
    v_pk_mul_f32 v[82:83], v[82:83], s[40:41]
    v_mfma_f32_16x16x32_bf16 v[100:103], a[4:7], a[84:87], v[100:103]
    v_pk_mul_f32 v[84:85], v[84:85], s[40:41]
    v_pk_mul_f32 v[86:87], v[86:87], s[40:41]
    v_mfma_f32_16x16x32_bf16 v[104:107], a[4:7], a[88:91], v[104:107]
    v_cvt_pk_bf16_f32 v80, v80, v81
    v_cvt_pk_bf16_f32 v81, v82, v83
    v_mfma_f32_16x16x32_bf16 v[108:111], a[4:7], a[92:95], v[108:111]
    v_cvt_pk_bf16_f32 v82, v84, v85
    v_cvt_pk_bf16_f32 v83, v86, v87
    v_mfma_f32_16x16x32_bf16 v[96:99], a[8:11], a[32:35], v[96:99]
    s_nop 1
    v_permlane16_swap_b32 v80, v82
    v_mfma_f32_16x16x32_bf16 v[100:103], a[8:11], a[36:39], v[100:103]
    v_permlane16_swap_b32 v81, v83
    s_nop 0
    v_mfma_f32_16x16x32_bf16 v[104:107], a[8:11], a[40:43], v[104:107]
    buffer_store_dwordx4 v[80:83], v14, s[28:31], s36 offen offset:3072 sc1
    v_pk_mul_f32 v[88:89], v[88:89], s[40:41]
    v_mfma_f32_16x16x32_bf16 v[108:111], a[8:11], a[44:47], v[108:111]
    v_pk_mul_f32 v[90:91], v[90:91], s[40:41]
    v_pk_mul_f32 v[92:93], v[92:93], s[40:41]
    v_mfma_f32_16x16x32_bf16 v[96:99], a[12:15], a[48:51], v[96:99]
    v_pk_mul_f32 v[94:95], v[94:95], s[40:41]
    v_cvt_pk_bf16_f32 v88, v88, v89
    v_mfma_f32_16x16x32_bf16 v[100:103], a[12:15], a[52:55], v[100:103]
    v_cvt_pk_bf16_f32 v89, v90, v91
    v_cvt_pk_bf16_f32 v90, v92, v93
    v_mfma_f32_16x16x32_bf16 v[104:107], a[12:15], a[56:59], v[104:107]
    v_cvt_pk_bf16_f32 v91, v94, v95
    s_nop 1
    v_mfma_f32_16x16x32_bf16 v[108:111], a[12:15], a[60:63], v[108:111]
    v_permlane16_swap_b32 v88, v90
    v_permlane16_swap_b32 v89, v91
    s_nop 0
    buffer_store_dwordx4 v[88:91], v14, s[28:31], s38 offen offset:3072 sc1
    s_waitcnt lgkmcnt(0)
    v_mfma_f32_16x16x32_bf16 v[112:115], a[16:19], a[64:67], v[112:115]
    ds_read_b64_tr_b16 a[0:1], v8 offset:17088
    ds_read_b64_tr_b16 a[2:3], v8 offset:17344
    v_mfma_f32_16x16x32_bf16 v[116:119], a[16:19], a[68:71], v[116:119]
    ds_read_b64_tr_b16 a[4:5], v8 offset:33984
    ds_read_b64_tr_b16 a[6:7], v8 offset:34240
    v_mfma_f32_16x16x32_bf16 v[120:123], a[16:19], a[72:75], v[120:123]
    ds_read_b64_tr_b16 a[8:9], v9 offset:192
    ds_read_b64_tr_b16 a[10:11], v9 offset:448
    v_mfma_f32_16x16x32_bf16 v[124:127], a[16:19], a[76:79], v[124:127]
    ds_read_b64_tr_b16 a[12:13], v9 offset:17088
    ds_read_b64_tr_b16 a[14:15], v9 offset:17344
    v_mfma_f32_16x16x32_bf16 v[112:115], a[20:23], a[80:83], v[112:115]
    v_pk_mul_f32 v[96:97], v[96:97], s[40:41]
    v_pk_mul_f32 v[98:99], v[98:99], s[40:41]
    v_mfma_f32_16x16x32_bf16 v[116:119], a[20:23], a[84:87], v[116:119]
    v_pk_mul_f32 v[100:101], v[100:101], s[40:41]
    v_pk_mul_f32 v[102:103], v[102:103], s[40:41]
    v_mfma_f32_16x16x32_bf16 v[120:123], a[20:23], a[88:91], v[120:123]
    v_cvt_pk_bf16_f32 v96, v96, v97
    v_cvt_pk_bf16_f32 v97, v98, v99
    v_mfma_f32_16x16x32_bf16 v[124:127], a[20:23], a[92:95], v[124:127]
    v_cvt_pk_bf16_f32 v98, v100, v101
    v_cvt_pk_bf16_f32 v99, v102, v103
    v_mfma_f32_16x16x32_bf16 v[112:115], a[24:27], a[32:35], v[112:115]
    s_nop 1
    v_permlane16_swap_b32 v96, v98
    v_mfma_f32_16x16x32_bf16 v[116:119], a[24:27], a[36:39], v[116:119]
    v_permlane16_swap_b32 v97, v99
    s_nop 0
    v_mfma_f32_16x16x32_bf16 v[120:123], a[24:27], a[40:43], v[120:123]
    buffer_store_dwordx4 v[96:99], v14, s[28:31], s37 offen offset:0 sc1
    v_pk_mul_f32 v[104:105], v[104:105], s[40:41]
    v_mfma_f32_16x16x32_bf16 v[124:127], a[24:27], a[44:47], v[124:127]
    v_pk_mul_f32 v[106:107], v[106:107], s[40:41]
    v_pk_mul_f32 v[108:109], v[108:109], s[40:41]
    v_mfma_f32_16x16x32_bf16 v[112:115], a[28:31], a[48:51], v[112:115]
    v_pk_mul_f32 v[110:111], v[110:111], s[40:41]
    v_cvt_pk_bf16_f32 v104, v104, v105
    v_mfma_f32_16x16x32_bf16 v[116:119], a[28:31], a[52:55], v[116:119]
    v_cvt_pk_bf16_f32 v105, v106, v107
    v_cvt_pk_bf16_f32 v106, v108, v109
    v_mfma_f32_16x16x32_bf16 v[120:123], a[28:31], a[56:59], v[120:123]
    v_cvt_pk_bf16_f32 v107, v110, v111
    s_nop 1
    v_mfma_f32_16x16x32_bf16 v[124:127], a[28:31], a[60:63], v[124:127]
    v_permlane16_swap_b32 v104, v106
    v_permlane16_swap_b32 v105, v107
    s_nop 0
    buffer_store_dwordx4 v[104:107], v14, s[28:31], s39 offen offset:0 sc1
    s_waitcnt lgkmcnt(0)
    v_mfma_f32_16x16x32_bf16 v[128:131], a[0:3], a[64:67], v[128:131]
    ds_read_b64_tr_b16 a[16:17], v8 offset:17120
    ds_read_b64_tr_b16 a[18:19], v8 offset:17376
    v_mfma_f32_16x16x32_bf16 v[132:135], a[0:3], a[68:71], v[132:135]
    ds_read_b64_tr_b16 a[20:21], v8 offset:34016
    ds_read_b64_tr_b16 a[22:23], v8 offset:34272
    v_mfma_f32_16x16x32_bf16 v[136:139], a[0:3], a[72:75], v[136:139]
    ds_read_b64_tr_b16 a[24:25], v9 offset:224
    ds_read_b64_tr_b16 a[26:27], v9 offset:480
    v_mfma_f32_16x16x32_bf16 v[140:143], a[0:3], a[76:79], v[140:143]
    ds_read_b64_tr_b16 a[28:29], v9 offset:17120
    ds_read_b64_tr_b16 a[30:31], v9 offset:17376
    v_mfma_f32_16x16x32_bf16 v[128:131], a[4:7], a[80:83], v[128:131]
    v_pk_mul_f32 v[112:113], v[112:113], s[40:41]
    v_pk_mul_f32 v[114:115], v[114:115], s[40:41]
    v_mfma_f32_16x16x32_bf16 v[132:135], a[4:7], a[84:87], v[132:135]
    v_pk_mul_f32 v[116:117], v[116:117], s[40:41]
    v_pk_mul_f32 v[118:119], v[118:119], s[40:41]
    v_mfma_f32_16x16x32_bf16 v[136:139], a[4:7], a[88:91], v[136:139]
    v_cvt_pk_bf16_f32 v112, v112, v113
    v_cvt_pk_bf16_f32 v113, v114, v115
    v_mfma_f32_16x16x32_bf16 v[140:143], a[4:7], a[92:95], v[140:143]
    v_cvt_pk_bf16_f32 v114, v116, v117
    v_cvt_pk_bf16_f32 v115, v118, v119
    v_mfma_f32_16x16x32_bf16 v[128:131], a[8:11], a[32:35], v[128:131]
    s_nop 1
    v_permlane16_swap_b32 v112, v114
    v_mfma_f32_16x16x32_bf16 v[132:135], a[8:11], a[36:39], v[132:135]
    v_permlane16_swap_b32 v113, v115
    s_nop 0
    v_mfma_f32_16x16x32_bf16 v[136:139], a[8:11], a[40:43], v[136:139]
    buffer_store_dwordx4 v[112:115], v14, s[28:31], s37 offen offset:1024 sc1
    v_pk_mul_f32 v[120:121], v[120:121], s[40:41]
    v_mfma_f32_16x16x32_bf16 v[140:143], a[8:11], a[44:47], v[140:143]
    v_pk_mul_f32 v[122:123], v[122:123], s[40:41]
    v_pk_mul_f32 v[124:125], v[124:125], s[40:41]
    v_mfma_f32_16x16x32_bf16 v[128:131], a[12:15], a[48:51], v[128:131]
    v_pk_mul_f32 v[126:127], v[126:127], s[40:41]
    v_cvt_pk_bf16_f32 v120, v120, v121
    v_mfma_f32_16x16x32_bf16 v[132:135], a[12:15], a[52:55], v[132:135]
    v_cvt_pk_bf16_f32 v121, v122, v123
    v_cvt_pk_bf16_f32 v122, v124, v125
    v_mfma_f32_16x16x32_bf16 v[136:139], a[12:15], a[56:59], v[136:139]
    v_cvt_pk_bf16_f32 v123, v126, v127
    s_nop 1
    v_mfma_f32_16x16x32_bf16 v[140:143], a[12:15], a[60:63], v[140:143]
    v_permlane16_swap_b32 v120, v122
    v_permlane16_swap_b32 v121, v123
    s_nop 0
    buffer_store_dwordx4 v[120:123], v14, s[28:31], s39 offen offset:1024 sc1
    s_waitcnt lgkmcnt(0)
    v_mfma_f32_16x16x32_bf16 v[144:147], a[16:19], a[64:67], v[144:147]
    s_nop 3
    s_nop 3
    v_mfma_f32_16x16x32_bf16 v[148:151], a[16:19], a[68:71], v[148:151]
    v_pk_mul_f32 v[128:129], v[128:129], s[40:41]
    v_pk_mul_f32 v[130:131], v[130:131], s[40:41]
    v_mfma_f32_16x16x32_bf16 v[152:155], a[16:19], a[72:75], v[152:155]
    v_pk_mul_f32 v[132:133], v[132:133], s[40:41]
    v_pk_mul_f32 v[134:135], v[134:135], s[40:41]
    v_mfma_f32_16x16x32_bf16 v[156:159], a[16:19], a[76:79], v[156:159]
    v_cvt_pk_bf16_f32 v128, v128, v129
    v_cvt_pk_bf16_f32 v129, v130, v131
    v_mfma_f32_16x16x32_bf16 v[144:147], a[20:23], a[80:83], v[144:147]
    v_cvt_pk_bf16_f32 v130, v132, v133
    v_cvt_pk_bf16_f32 v131, v134, v135
    v_mfma_f32_16x16x32_bf16 v[148:151], a[20:23], a[84:87], v[148:151]
    s_nop 1
    v_permlane16_swap_b32 v128, v130
    v_mfma_f32_16x16x32_bf16 v[152:155], a[20:23], a[88:91], v[152:155]
    v_permlane16_swap_b32 v129, v131
    s_nop 0
    v_mfma_f32_16x16x32_bf16 v[156:159], a[20:23], a[92:95], v[156:159]
    buffer_store_dwordx4 v[128:131], v14, s[28:31], s37 offen offset:2048 sc1
    v_pk_mul_f32 v[136:137], v[136:137], s[40:41]
    v_mfma_f32_16x16x32_bf16 v[144:147], a[24:27], a[32:35], v[144:147]
    v_pk_mul_f32 v[138:139], v[138:139], s[40:41]
    v_pk_mul_f32 v[140:141], v[140:141], s[40:41]
    v_mfma_f32_16x16x32_bf16 v[148:151], a[24:27], a[36:39], v[148:151]
    v_pk_mul_f32 v[142:143], v[142:143], s[40:41]
    v_cvt_pk_bf16_f32 v136, v136, v137
    v_mfma_f32_16x16x32_bf16 v[152:155], a[24:27], a[40:43], v[152:155]
    v_cvt_pk_bf16_f32 v137, v138, v139
    v_cvt_pk_bf16_f32 v138, v140, v141
    v_mfma_f32_16x16x32_bf16 v[156:159], a[24:27], a[44:47], v[156:159]
    v_cvt_pk_bf16_f32 v139, v142, v143
    s_nop 1
    v_mfma_f32_16x16x32_bf16 v[144:147], a[28:31], a[48:51], v[144:147]
    v_permlane16_swap_b32 v136, v138
    v_permlane16_swap_b32 v137, v139
    v_mfma_f32_16x16x32_bf16 v[148:151], a[28:31], a[52:55], v[148:151]
    s_nop 0
    buffer_store_dwordx4 v[136:139], v14, s[28:31], s39 offen offset:2048 sc1
    v_mfma_f32_16x16x32_bf16 v[152:155], a[28:31], a[56:59], v[152:155]
    v_mfma_f32_16x16x32_bf16 v[156:159], a[28:31], a[60:63], v[156:159]
    s_nop 7
    s_nop 3
    s_nop 3
    v_pk_mul_f32 v[144:145], v[144:145], s[40:41]
    v_pk_mul_f32 v[146:147], v[146:147], s[40:41]
    v_pk_mul_f32 v[148:149], v[148:149], s[40:41]
    v_pk_mul_f32 v[150:151], v[150:151], s[40:41]
    v_cvt_pk_bf16_f32 v144, v144, v145
    v_cvt_pk_bf16_f32 v145, v146, v147
    v_cvt_pk_bf16_f32 v146, v148, v149
    v_cvt_pk_bf16_f32 v147, v150, v151
    s_nop 1
    v_permlane16_swap_b32 v144, v146
    v_permlane16_swap_b32 v145, v147
    s_nop 0
    buffer_store_dwordx4 v[144:147], v14, s[28:31], s37 offen offset:3072 sc1
    v_pk_mul_f32 v[152:153], v[152:153], s[40:41]
    v_pk_mul_f32 v[154:155], v[154:155], s[40:41]
    v_pk_mul_f32 v[156:157], v[156:157], s[40:41]
    v_pk_mul_f32 v[158:159], v[158:159], s[40:41]
    v_cvt_pk_bf16_f32 v152, v152, v153
    v_cvt_pk_bf16_f32 v153, v154, v155
    v_cvt_pk_bf16_f32 v154, v156, v157
    v_cvt_pk_bf16_f32 v155, v158, v159
    s_nop 1
    v_permlane16_swap_b32 v152, v154
    v_permlane16_swap_b32 v153, v155
    s_nop 0
    buffer_store_dwordx4 v[152:155], v14, s[28:31], s39 offen offset:3072 sc1
    s_endpgm
K1_PRE_N:
    s_barrier
    ds_read_b128 a[64:67], v12 offset:0
    ds_read_b128 a[68:71], v12 offset:2048
    ds_read_b128 a[72:75], v12 offset:4096
    ds_read_b128 a[76:79], v12 offset:6144
    ds_read_b64_tr_b16 a[0:1], v9 offset:0
    ds_read_b64_tr_b16 a[2:3], v9 offset:256
    ds_read_b64_tr_b16 a[4:5], v9 offset:32
    ds_read_b64_tr_b16 a[6:7], v9 offset:288
    ds_read_b64_tr_b16 a[8:9], v9 offset:64
    ds_read_b64_tr_b16 a[10:11], v9 offset:320
    ds_read_b64_tr_b16 a[12:13], v9 offset:96
    ds_read_b64_tr_b16 a[14:15], v9 offset:352
    ds_read_b64_tr_b16 a[16:17], v9 offset:128
    ds_read_b64_tr_b16 a[18:19], v9 offset:384
    ds_read_b64_tr_b16 a[20:21], v9 offset:160
    ds_read_b64_tr_b16 a[22:23], v9 offset:416
    ds_read_b64_tr_b16 a[24:25], v9 offset:192
    ds_read_b64_tr_b16 a[26:27], v9 offset:448
    ds_read_b64_tr_b16 a[28:29], v9 offset:224
    ds_read_b64_tr_b16 a[30:31], v9 offset:480
.p2align 3
K1_LOOP_N:
    v_add_u32 v9, s32, v8
    s_waitcnt lgkmcnt(0)
    s_barrier
    v_mfma_f32_16x16x32_bf16 v[32:35], a[64:67], a[0:3], v[32:35]
    ds_read_b128 a[80:83], v13 offset:0
    v_mfma_f32_16x16x32_bf16 v[36:39], a[68:71], a[0:3], v[36:39]
    ds_read_b128 a[84:87], v13 offset:2048
    v_mfma_f32_16x16x32_bf16 v[40:43], a[72:75], a[0:3], v[40:43]
    ds_read_b128 a[88:91], v13 offset:4096
    v_mfma_f32_16x16x32_bf16 v[44:47], a[76:79], a[0:3], v[44:47]
    ds_read_b128 a[92:95], v13 offset:6144
    v_mfma_f32_16x16x32_bf16 v[48:51], a[64:67], a[4:7], v[48:51]
    ds_read_b64_tr_b16 a[32:33], v9 offset:0
    v_mfma_f32_16x16x32_bf16 v[52:55], a[68:71], a[4:7], v[52:55]
    ds_read_b64_tr_b16 a[34:35], v9 offset:256
    v_mfma_f32_16x16x32_bf16 v[56:59], a[72:75], a[4:7], v[56:59]
    ds_read_b64_tr_b16 a[36:37], v9 offset:32
    v_mfma_f32_16x16x32_bf16 v[60:63], a[76:79], a[4:7], v[60:63]
    ds_read_b64_tr_b16 a[38:39], v9 offset:288
    v_mfma_f32_16x16x32_bf16 v[64:67], a[64:67], a[8:11], v[64:67]
    ds_read_b64_tr_b16 a[40:41], v9 offset:64
    v_mfma_f32_16x16x32_bf16 v[68:71], a[68:71], a[8:11], v[68:71]
    ds_read_b64_tr_b16 a[42:43], v9 offset:320
    v_mfma_f32_16x16x32_bf16 v[72:75], a[72:75], a[8:11], v[72:75]
    ds_read_b64_tr_b16 a[44:45], v9 offset:96
    v_mfma_f32_16x16x32_bf16 v[76:79], a[76:79], a[8:11], v[76:79]
    ds_read_b64_tr_b16 a[46:47], v9 offset:352
    v_mfma_f32_16x16x32_bf16 v[80:83], a[64:67], a[12:15], v[80:83]
    ds_read_b64_tr_b16 a[48:49], v9 offset:128
    v_mfma_f32_16x16x32_bf16 v[84:87], a[68:71], a[12:15], v[84:87]
    ds_read_b64_tr_b16 a[50:51], v9 offset:384
    v_mfma_f32_16x16x32_bf16 v[88:91], a[72:75], a[12:15], v[88:91]
    ds_read_b64_tr_b16 a[52:53], v9 offset:160
    v_mfma_f32_16x16x32_bf16 v[92:95], a[76:79], a[12:15], v[92:95]
    ds_read_b64_tr_b16 a[54:55], v9 offset:416
    v_mfma_f32_16x16x32_bf16 v[96:99], a[64:67], a[16:19], v[96:99]
    ds_read_b64_tr_b16 a[56:57], v9 offset:192
    v_mfma_f32_16x16x32_bf16 v[100:103], a[68:71], a[16:19], v[100:103]
    ds_read_b64_tr_b16 a[58:59], v9 offset:448
    v_mfma_f32_16x16x32_bf16 v[104:107], a[72:75], a[16:19], v[104:107]
    ds_read_b64_tr_b16 a[60:61], v9 offset:224
    v_mfma_f32_16x16x32_bf16 v[108:111], a[76:79], a[16:19], v[108:111]
    ds_read_b64_tr_b16 a[62:63], v9 offset:480
    v_mfma_f32_16x16x32_bf16 v[112:115], a[64:67], a[20:23], v[112:115]
    s_add_u32 s32, s32, 16896
    v_mfma_f32_16x16x32_bf16 v[116:119], a[68:71], a[20:23], v[116:119]
    s_cmp_ge_u32 s32, 84480
    v_mfma_f32_16x16x32_bf16 v[120:123], a[72:75], a[20:23], v[120:123]
    s_cselect_b32 s32, 0, s32
    v_mfma_f32_16x16x32_bf16 v[124:127], a[76:79], a[20:23], v[124:127]
    v_mfma_f32_16x16x32_bf16 v[128:131], a[64:67], a[24:27], v[128:131]
    v_mfma_f32_16x16x32_bf16 v[132:135], a[68:71], a[24:27], v[132:135]
    v_mfma_f32_16x16x32_bf16 v[136:139], a[72:75], a[24:27], v[136:139]
    v_mfma_f32_16x16x32_bf16 v[140:143], a[76:79], a[24:27], v[140:143]
    v_mfma_f32_16x16x32_bf16 v[144:147], a[64:67], a[28:31], v[144:147]
    v_mfma_f32_16x16x32_bf16 v[148:151], a[68:71], a[28:31], v[148:151]
    v_mfma_f32_16x16x32_bf16 v[152:155], a[72:75], a[28:31], v[152:155]
    v_mfma_f32_16x16x32_bf16 v[156:159], a[76:79], a[28:31], v[156:159]
    v_add_u32 v9, s32, v8
    v_add_u32 v12, s33, v10
    s_waitcnt lgkmcnt(0)
    s_barrier
    v_mfma_f32_16x16x32_bf16 v[32:35], a[80:83], a[32:35], v[32:35]
    ds_read_b128 a[64:67], v12 offset:0
    v_mfma_f32_16x16x32_bf16 v[36:39], a[84:87], a[32:35], v[36:39]
    ds_read_b128 a[68:71], v12 offset:2048
    v_mfma_f32_16x16x32_bf16 v[40:43], a[88:91], a[32:35], v[40:43]
    ds_read_b128 a[72:75], v12 offset:4096
    v_mfma_f32_16x16x32_bf16 v[44:47], a[92:95], a[32:35], v[44:47]
    ds_read_b128 a[76:79], v12 offset:6144
    v_mfma_f32_16x16x32_bf16 v[48:51], a[80:83], a[36:39], v[48:51]
    ds_read_b64_tr_b16 a[0:1], v9 offset:0
    v_mfma_f32_16x16x32_bf16 v[52:55], a[84:87], a[36:39], v[52:55]
    ds_read_b64_tr_b16 a[2:3], v9 offset:256
    v_mfma_f32_16x16x32_bf16 v[56:59], a[88:91], a[36:39], v[56:59]
    ds_read_b64_tr_b16 a[4:5], v9 offset:32
    v_mfma_f32_16x16x32_bf16 v[60:63], a[92:95], a[36:39], v[60:63]
    ds_read_b64_tr_b16 a[6:7], v9 offset:288
    v_mfma_f32_16x16x32_bf16 v[64:67], a[80:83], a[40:43], v[64:67]
    ds_read_b64_tr_b16 a[8:9], v9 offset:64
    v_mfma_f32_16x16x32_bf16 v[68:71], a[84:87], a[40:43], v[68:71]
    ds_read_b64_tr_b16 a[10:11], v9 offset:320
    v_mfma_f32_16x16x32_bf16 v[72:75], a[88:91], a[40:43], v[72:75]
    ds_read_b64_tr_b16 a[12:13], v9 offset:96
    v_mfma_f32_16x16x32_bf16 v[76:79], a[92:95], a[40:43], v[76:79]
    ds_read_b64_tr_b16 a[14:15], v9 offset:352
    v_mfma_f32_16x16x32_bf16 v[80:83], a[80:83], a[44:47], v[80:83]
    ds_read_b64_tr_b16 a[16:17], v9 offset:128
    v_mfma_f32_16x16x32_bf16 v[84:87], a[84:87], a[44:47], v[84:87]
    ds_read_b64_tr_b16 a[18:19], v9 offset:384
    v_mfma_f32_16x16x32_bf16 v[88:91], a[88:91], a[44:47], v[88:91]
    ds_read_b64_tr_b16 a[20:21], v9 offset:160
    v_mfma_f32_16x16x32_bf16 v[92:95], a[92:95], a[44:47], v[92:95]
    ds_read_b64_tr_b16 a[22:23], v9 offset:416
    v_mfma_f32_16x16x32_bf16 v[96:99], a[80:83], a[48:51], v[96:99]
    ds_read_b64_tr_b16 a[24:25], v9 offset:192
    v_mfma_f32_16x16x32_bf16 v[100:103], a[84:87], a[48:51], v[100:103]
    ds_read_b64_tr_b16 a[26:27], v9 offset:448
    v_mfma_f32_16x16x32_bf16 v[104:107], a[88:91], a[48:51], v[104:107]
    ds_read_b64_tr_b16 a[28:29], v9 offset:224
    v_mfma_f32_16x16x32_bf16 v[108:111], a[92:95], a[48:51], v[108:111]
    ds_read_b64_tr_b16 a[30:31], v9 offset:480
    v_mfma_f32_16x16x32_bf16 v[112:115], a[80:83], a[52:55], v[112:115]
    s_add_u32 s32, s32, 16896
    v_mfma_f32_16x16x32_bf16 v[116:119], a[84:87], a[52:55], v[116:119]
    s_cmp_ge_u32 s32, 84480
    v_mfma_f32_16x16x32_bf16 v[120:123], a[88:91], a[52:55], v[120:123]
    s_cselect_b32 s32, 0, s32
    v_mfma_f32_16x16x32_bf16 v[124:127], a[92:95], a[52:55], v[124:127]
    v_add_u32 v13, s33, v11
    v_mfma_f32_16x16x32_bf16 v[128:131], a[80:83], a[56:59], v[128:131]
    s_add_u32 s33, s33, 16384
    v_mfma_f32_16x16x32_bf16 v[132:135], a[84:87], a[56:59], v[132:135]
    s_cmp_ge_u32 s33, 49152
    v_mfma_f32_16x16x32_bf16 v[136:139], a[88:91], a[56:59], v[136:139]
    s_cselect_b32 s33, 0, s33
    v_mfma_f32_16x16x32_bf16 v[140:143], a[92:95], a[56:59], v[140:143]
    s_add_u32 s34, s34, 1
    v_mfma_f32_16x16x32_bf16 v[144:147], a[80:83], a[60:63], v[144:147]
    s_cmp_lt_u32 s34, 8
    v_mfma_f32_16x16x32_bf16 v[148:151], a[84:87], a[60:63], v[148:151]
    v_mfma_f32_16x16x32_bf16 v[152:155], a[88:91], a[60:63], v[152:155]
    v_mfma_f32_16x16x32_bf16 v[156:159], a[92:95], a[60:63], v[156:159]
    s_cbranch_scc1 K1_LOOP_N
    s_lshl_b32 s3, s17, 11
    s_add_u32 s36, s36, s3
    s_add_u32 s38, s36, 40960
    v_mul_u32_u24 v5, 10240, v4
    v_lshl_add_u32 v14, v3, 4, v5
    s_nop 7

    v_add_u32 v9, 50688, v8
    s_waitcnt lgkmcnt(0)
    s_barrier
    s_barrier
    s_barrier
    s_barrier
    ds_read_b64_tr_b16 a[0:1], v8 offset:16896
    ds_read_b64_tr_b16 a[2:3], v8 offset:17152
    ds_read_b64_tr_b16 a[4:5], v8 offset:33792
    ds_read_b64_tr_b16 a[6:7], v8 offset:34048
    ds_read_b64_tr_b16 a[8:9], v9 offset:0
    ds_read_b64_tr_b16 a[10:11], v9 offset:256
    ds_read_b64_tr_b16 a[12:13], v9 offset:16896
    ds_read_b64_tr_b16 a[14:15], v9 offset:17152
    ds_read_b128 a[80:83], v11 offset:32768
    ds_read_b128 a[84:87], v11 offset:34816
    ds_read_b128 a[88:91], v11 offset:36864
    ds_read_b128 a[92:95], v11 offset:38912
    ds_read_b128 a[32:35], v10 offset:0
    ds_read_b128 a[36:39], v10 offset:2048
    ds_read_b128 a[40:43], v10 offset:4096
    ds_read_b128 a[44:47], v10 offset:6144
    ds_read_b128 a[48:51], v11 offset:0
    ds_read_b128 a[52:55], v11 offset:2048
    ds_read_b128 a[56:59], v11 offset:4096
    ds_read_b128 a[60:63], v11 offset:6144
    s_waitcnt lgkmcnt(12)
    v_mfma_f32_16x16x32_bf16 v[32:35], a[64:67], a[0:3], v[32:35]
    ds_read_b64_tr_b16 a[16:17], v8 offset:16928
    ds_read_b64_tr_b16 a[18:19], v8 offset:17184
    v_mfma_f32_16x16x32_bf16 v[36:39], a[68:71], a[0:3], v[36:39]
    ds_read_b64_tr_b16 a[20:21], v8 offset:33824
    ds_read_b64_tr_b16 a[22:23], v8 offset:34080
    v_mfma_f32_16x16x32_bf16 v[40:43], a[72:75], a[0:3], v[40:43]
    ds_read_b64_tr_b16 a[24:25], v9 offset:32
    ds_read_b64_tr_b16 a[26:27], v9 offset:288
    v_mfma_f32_16x16x32_bf16 v[44:47], a[76:79], a[0:3], v[44:47]
    ds_read_b64_tr_b16 a[28:29], v9 offset:16928
    ds_read_b64_tr_b16 a[30:31], v9 offset:17184
    s_waitcnt lgkmcnt(15)
    v_mfma_f32_16x16x32_bf16 v[32:35], a[80:83], a[4:7], v[32:35]
    v_mfma_f32_16x16x32_bf16 v[36:39], a[84:87], a[4:7], v[36:39]
    v_mfma_f32_16x16x32_bf16 v[40:43], a[88:91], a[4:7], v[40:43]
    v_mfma_f32_16x16x32_bf16 v[44:47], a[92:95], a[4:7], v[44:47]
    s_waitcnt lgkmcnt(12)
    v_mfma_f32_16x16x32_bf16 v[32:35], a[32:35], a[8:11], v[32:35]
    v_mfma_f32_16x16x32_bf16 v[36:39], a[36:39], a[8:11], v[36:39]
    v_mfma_f32_16x16x32_bf16 v[40:43], a[40:43], a[8:11], v[40:43]
    v_mfma_f32_16x16x32_bf16 v[44:47], a[44:47], a[8:11], v[44:47]
    s_waitcnt lgkmcnt(8)
    v_mfma_f32_16x16x32_bf16 v[32:35], a[48:51], a[12:15], v[32:35]
    v_mfma_f32_16x16x32_bf16 v[36:39], a[52:55], a[12:15], v[36:39]
    v_mfma_f32_16x16x32_bf16 v[40:43], a[56:59], a[12:15], v[40:43]
    v_mfma_f32_16x16x32_bf16 v[44:47], a[60:63], a[12:15], v[44:47]
    s_waitcnt lgkmcnt(0)
    v_mfma_f32_16x16x32_bf16 v[48:51], a[64:67], a[16:19], v[48:51]
    ds_read_b64_tr_b16 a[0:1], v8 offset:16960
    ds_read_b64_tr_b16 a[2:3], v8 offset:17216
    v_mfma_f32_16x16x32_bf16 v[52:55], a[68:71], a[16:19], v[52:55]
    ds_read_b64_tr_b16 a[4:5], v8 offset:33856
    ds_read_b64_tr_b16 a[6:7], v8 offset:34112
    v_mfma_f32_16x16x32_bf16 v[56:59], a[72:75], a[16:19], v[56:59]
    ds_read_b64_tr_b16 a[8:9], v9 offset:64
    ds_read_b64_tr_b16 a[10:11], v9 offset:320
    v_mfma_f32_16x16x32_bf16 v[60:63], a[76:79], a[16:19], v[60:63]
    ds_read_b64_tr_b16 a[12:13], v9 offset:16960
    ds_read_b64_tr_b16 a[14:15], v9 offset:17216
    v_mfma_f32_16x16x32_bf16 v[48:51], a[80:83], a[20:23], v[48:51]
    v_cvt_pk_bf16_f32 v32, v32, v33
    v_cvt_pk_bf16_f32 v33, v34, v35
    v_mfma_f32_16x16x32_bf16 v[52:55], a[84:87], a[20:23], v[52:55]
    v_cvt_pk_bf16_f32 v34, v36, v37
    v_cvt_pk_bf16_f32 v35, v38, v39
    v_mfma_f32_16x16x32_bf16 v[56:59], a[88:91], a[20:23], v[56:59]
    s_nop 1
    v_permlane32_swap_b32 v32, v34
    v_mfma_f32_16x16x32_bf16 v[60:63], a[92:95], a[20:23], v[60:63]
    v_permlane32_swap_b32 v33, v35
    s_nop 0
    v_mfma_f32_16x16x32_bf16 v[48:51], a[32:35], a[24:27], v[48:51]
    buffer_store_dwordx4 v[32:35], v14, s[28:31], s36 offen offset:0 sc1
    v_cvt_pk_bf16_f32 v40, v40, v41
    v_mfma_f32_16x16x32_bf16 v[52:55], a[36:39], a[24:27], v[52:55]
    v_cvt_pk_bf16_f32 v41, v42, v43
    v_cvt_pk_bf16_f32 v42, v44, v45
    v_mfma_f32_16x16x32_bf16 v[56:59], a[40:43], a[24:27], v[56:59]
    v_cvt_pk_bf16_f32 v43, v46, v47
    s_nop 1
    v_mfma_f32_16x16x32_bf16 v[60:63], a[44:47], a[24:27], v[60:63]
    v_permlane32_swap_b32 v40, v42
    v_permlane32_swap_b32 v41, v43
    v_mfma_f32_16x16x32_bf16 v[48:51], a[48:51], a[28:31], v[48:51]
    s_nop 0
    buffer_store_dwordx4 v[40:43], v14, s[28:31], s38 offen offset:0 sc1
    v_mfma_f32_16x16x32_bf16 v[52:55], a[52:55], a[28:31], v[52:55]
    v_mfma_f32_16x16x32_bf16 v[56:59], a[56:59], a[28:31], v[56:59]
    v_mfma_f32_16x16x32_bf16 v[60:63], a[60:63], a[28:31], v[60:63]
    s_waitcnt lgkmcnt(0)
    v_mfma_f32_16x16x32_bf16 v[64:67], a[64:67], a[0:3], v[64:67]
    ds_read_b64_tr_b16 a[16:17], v8 offset:16992
    ds_read_b64_tr_b16 a[18:19], v8 offset:17248
    v_mfma_f32_16x16x32_bf16 v[68:71], a[68:71], a[0:3], v[68:71]
    ds_read_b64_tr_b16 a[20:21], v8 offset:33888
    ds_read_b64_tr_b16 a[22:23], v8 offset:34144
    v_mfma_f32_16x16x32_bf16 v[72:75], a[72:75], a[0:3], v[72:75]
    ds_read_b64_tr_b16 a[24:25], v9 offset:96
    ds_read_b64_tr_b16 a[26:27], v9 offset:352
    v_mfma_f32_16x16x32_bf16 v[76:79], a[76:79], a[0:3], v[76:79]
    ds_read_b64_tr_b16 a[28:29], v9 offset:16992
    ds_read_b64_tr_b16 a[30:31], v9 offset:17248
    v_mfma_f32_16x16x32_bf16 v[64:67], a[80:83], a[4:7], v[64:67]
    v_cvt_pk_bf16_f32 v48, v48, v49
    v_cvt_pk_bf16_f32 v49, v50, v51
    v_mfma_f32_16x16x32_bf16 v[68:71], a[84:87], a[4:7], v[68:71]
    v_cvt_pk_bf16_f32 v50, v52, v53
    v_cvt_pk_bf16_f32 v51, v54, v55
    v_mfma_f32_16x16x32_bf16 v[72:75], a[88:91], a[4:7], v[72:75]
    s_nop 1
    v_permlane32_swap_b32 v48, v50
    v_mfma_f32_16x16x32_bf16 v[76:79], a[92:95], a[4:7], v[76:79]
    v_permlane32_swap_b32 v49, v51
    s_nop 0
    v_mfma_f32_16x16x32_bf16 v[64:67], a[32:35], a[8:11], v[64:67]
    buffer_store_dwordx4 v[48:51], v14, s[28:31], s36 offen offset:256 sc1
    v_cvt_pk_bf16_f32 v56, v56, v57
    v_mfma_f32_16x16x32_bf16 v[68:71], a[36:39], a[8:11], v[68:71]
    v_cvt_pk_bf16_f32 v57, v58, v59
    v_cvt_pk_bf16_f32 v58, v60, v61
    v_mfma_f32_16x16x32_bf16 v[72:75], a[40:43], a[8:11], v[72:75]
    v_cvt_pk_bf16_f32 v59, v62, v63
    s_nop 1
    v_mfma_f32_16x16x32_bf16 v[76:79], a[44:47], a[8:11], v[76:79]
    v_permlane32_swap_b32 v56, v58
    v_permlane32_swap_b32 v57, v59
    v_mfma_f32_16x16x32_bf16 v[64:67], a[48:51], a[12:15], v[64:67]
    s_nop 0
    buffer_store_dwordx4 v[56:59], v14, s[28:31], s38 offen offset:256 sc1
    v_mfma_f32_16x16x32_bf16 v[68:71], a[52:55], a[12:15], v[68:71]
    v_mfma_f32_16x16x32_bf16 v[72:75], a[56:59], a[12:15], v[72:75]
    v_mfma_f32_16x16x32_bf16 v[76:79], a[60:63], a[12:15], v[76:79]
    s_waitcnt lgkmcnt(0)
    v_mfma_f32_16x16x32_bf16 v[80:83], a[64:67], a[16:19], v[80:83]
    ds_read_b64_tr_b16 a[0:1], v8 offset:17024
    ds_read_b64_tr_b16 a[2:3], v8 offset:17280
    v_mfma_f32_16x16x32_bf16 v[84:87], a[68:71], a[16:19], v[84:87]
    ds_read_b64_tr_b16 a[4:5], v8 offset:33920
    ds_read_b64_tr_b16 a[6:7], v8 offset:34176
    v_mfma_f32_16x16x32_bf16 v[88:91], a[72:75], a[16:19], v[88:91]
    ds_read_b64_tr_b16 a[8:9], v9 offset:128
    ds_read_b64_tr_b16 a[10:11], v9 offset:384
    v_mfma_f32_16x16x32_bf16 v[92:95], a[76:79], a[16:19], v[92:95]
    ds_read_b64_tr_b16 a[12:13], v9 offset:17024
    ds_read_b64_tr_b16 a[14:15], v9 offset:17280
    v_mfma_f32_16x16x32_bf16 v[80:83], a[80:83], a[20:23], v[80:83]
    v_cvt_pk_bf16_f32 v64, v64, v65
    v_cvt_pk_bf16_f32 v65, v66, v67
    v_mfma_f32_16x16x32_bf16 v[84:87], a[84:87], a[20:23], v[84:87]
    v_cvt_pk_bf16_f32 v66, v68, v69
    v_cvt_pk_bf16_f32 v67, v70, v71
    v_mfma_f32_16x16x32_bf16 v[88:91], a[88:91], a[20:23], v[88:91]
    s_nop 1
    v_permlane32_swap_b32 v64, v66
    v_mfma_f32_16x16x32_bf16 v[92:95], a[92:95], a[20:23], v[92:95]
    v_permlane32_swap_b32 v65, v67
    s_nop 0
    v_mfma_f32_16x16x32_bf16 v[80:83], a[32:35], a[24:27], v[80:83]
    buffer_store_dwordx4 v[64:67], v14, s[28:31], s36 offen offset:512 sc1
    v_cvt_pk_bf16_f32 v72, v72, v73
    v_mfma_f32_16x16x32_bf16 v[84:87], a[36:39], a[24:27], v[84:87]
    v_cvt_pk_bf16_f32 v73, v74, v75
    v_cvt_pk_bf16_f32 v74, v76, v77
    v_mfma_f32_16x16x32_bf16 v[88:91], a[40:43], a[24:27], v[88:91]
    v_cvt_pk_bf16_f32 v75, v78, v79
    s_nop 1
    v_mfma_f32_16x16x32_bf16 v[92:95], a[44:47], a[24:27], v[92:95]
    v_permlane32_swap_b32 v72, v74
    v_permlane32_swap_b32 v73, v75
    v_mfma_f32_16x16x32_bf16 v[80:83], a[48:51], a[28:31], v[80:83]
    s_nop 0
    buffer_store_dwordx4 v[72:75], v14, s[28:31], s38 offen offset:512 sc1
    v_mfma_f32_16x16x32_bf16 v[84:87], a[52:55], a[28:31], v[84:87]
    v_mfma_f32_16x16x32_bf16 v[88:91], a[56:59], a[28:31], v[88:91]
    v_mfma_f32_16x16x32_bf16 v[92:95], a[60:63], a[28:31], v[92:95]
    s_waitcnt lgkmcnt(0)
    v_mfma_f32_16x16x32_bf16 v[96:99], a[64:67], a[0:3], v[96:99]
    ds_read_b64_tr_b16 a[16:17], v8 offset:17056
    ds_read_b64_tr_b16 a[18:19], v8 offset:17312
    v_mfma_f32_16x16x32_bf16 v[100:103], a[68:71], a[0:3], v[100:103]
    ds_read_b64_tr_b16 a[20:21], v8 offset:33952
    ds_read_b64_tr_b16 a[22:23], v8 offset:34208
    v_mfma_f32_16x16x32_bf16 v[104:107], a[72:75], a[0:3], v[104:107]
    ds_read_b64_tr_b16 a[24:25], v9 offset:160
    ds_read_b64_tr_b16 a[26:27], v9 offset:416
    v_mfma_f32_16x16x32_bf16 v[108:111], a[76:79], a[0:3], v[108:111]
    ds_read_b64_tr_b16 a[28:29], v9 offset:17056
    ds_read_b64_tr_b16 a[30:31], v9 offset:17312
    v_mfma_f32_16x16x32_bf16 v[96:99], a[80:83], a[4:7], v[96:99]
    v_cvt_pk_bf16_f32 v80, v80, v81
    v_cvt_pk_bf16_f32 v81, v82, v83
    v_mfma_f32_16x16x32_bf16 v[100:103], a[84:87], a[4:7], v[100:103]
    v_cvt_pk_bf16_f32 v82, v84, v85
    v_cvt_pk_bf16_f32 v83, v86, v87
    v_mfma_f32_16x16x32_bf16 v[104:107], a[88:91], a[4:7], v[104:107]
    s_nop 1
    v_permlane32_swap_b32 v80, v82
    v_mfma_f32_16x16x32_bf16 v[108:111], a[92:95], a[4:7], v[108:111]
    v_permlane32_swap_b32 v81, v83
    s_nop 0
    v_mfma_f32_16x16x32_bf16 v[96:99], a[32:35], a[8:11], v[96:99]
    buffer_store_dwordx4 v[80:83], v14, s[28:31], s36 offen offset:768 sc1
    v_cvt_pk_bf16_f32 v88, v88, v89
    v_mfma_f32_16x16x32_bf16 v[100:103], a[36:39], a[8:11], v[100:103]
    v_cvt_pk_bf16_f32 v89, v90, v91
    v_cvt_pk_bf16_f32 v90, v92, v93
    v_mfma_f32_16x16x32_bf16 v[104:107], a[40:43], a[8:11], v[104:107]
    v_cvt_pk_bf16_f32 v91, v94, v95
    s_nop 1
    v_mfma_f32_16x16x32_bf16 v[108:111], a[44:47], a[8:11], v[108:111]
    v_permlane32_swap_b32 v88, v90
    v_permlane32_swap_b32 v89, v91
    v_mfma_f32_16x16x32_bf16 v[96:99], a[48:51], a[12:15], v[96:99]
    s_nop 0
    buffer_store_dwordx4 v[88:91], v14, s[28:31], s38 offen offset:768 sc1
    v_mfma_f32_16x16x32_bf16 v[100:103], a[52:55], a[12:15], v[100:103]
    v_mfma_f32_16x16x32_bf16 v[104:107], a[56:59], a[12:15], v[104:107]
    v_mfma_f32_16x16x32_bf16 v[108:111], a[60:63], a[12:15], v[108:111]
    s_waitcnt lgkmcnt(0)
    v_mfma_f32_16x16x32_bf16 v[112:115], a[64:67], a[16:19], v[112:115]
    ds_read_b64_tr_b16 a[0:1], v8 offset:17088
    ds_read_b64_tr_b16 a[2:3], v8 offset:17344
    v_mfma_f32_16x16x32_bf16 v[116:119], a[68:71], a[16:19], v[116:119]
    ds_read_b64_tr_b16 a[4:5], v8 offset:33984
    ds_read_b64_tr_b16 a[6:7], v8 offset:34240
    v_mfma_f32_16x16x32_bf16 v[120:123], a[72:75], a[16:19], v[120:123]
    ds_read_b64_tr_b16 a[8:9], v9 offset:192
    ds_read_b64_tr_b16 a[10:11], v9 offset:448
    v_mfma_f32_16x16x32_bf16 v[124:127], a[76:79], a[16:19], v[124:127]
    ds_read_b64_tr_b16 a[12:13], v9 offset:17088
    ds_read_b64_tr_b16 a[14:15], v9 offset:17344
    v_mfma_f32_16x16x32_bf16 v[112:115], a[80:83], a[20:23], v[112:115]
    v_cvt_pk_bf16_f32 v96, v96, v97
    v_cvt_pk_bf16_f32 v97, v98, v99
    v_mfma_f32_16x16x32_bf16 v[116:119], a[84:87], a[20:23], v[116:119]
    v_cvt_pk_bf16_f32 v98, v100, v101
    v_cvt_pk_bf16_f32 v99, v102, v103
    v_mfma_f32_16x16x32_bf16 v[120:123], a[88:91], a[20:23], v[120:123]
    s_nop 1
    v_permlane32_swap_b32 v96, v98
    v_mfma_f32_16x16x32_bf16 v[124:127], a[92:95], a[20:23], v[124:127]
    v_permlane32_swap_b32 v97, v99
    s_nop 0
    v_mfma_f32_16x16x32_bf16 v[112:115], a[32:35], a[24:27], v[112:115]
    buffer_store_dwordx4 v[96:99], v14, s[28:31], s36 offen offset:1024 sc1
    v_cvt_pk_bf16_f32 v104, v104, v105
    v_mfma_f32_16x16x32_bf16 v[116:119], a[36:39], a[24:27], v[116:119]
    v_cvt_pk_bf16_f32 v105, v106, v107
    v_cvt_pk_bf16_f32 v106, v108, v109
    v_mfma_f32_16x16x32_bf16 v[120:123], a[40:43], a[24:27], v[120:123]
    v_cvt_pk_bf16_f32 v107, v110, v111
    s_nop 1
    v_mfma_f32_16x16x32_bf16 v[124:127], a[44:47], a[24:27], v[124:127]
    v_permlane32_swap_b32 v104, v106
    v_permlane32_swap_b32 v105, v107
    v_mfma_f32_16x16x32_bf16 v[112:115], a[48:51], a[28:31], v[112:115]
    s_nop 0
    buffer_store_dwordx4 v[104:107], v14, s[28:31], s38 offen offset:1024 sc1
    v_mfma_f32_16x16x32_bf16 v[116:119], a[52:55], a[28:31], v[116:119]
    v_mfma_f32_16x16x32_bf16 v[120:123], a[56:59], a[28:31], v[120:123]
    v_mfma_f32_16x16x32_bf16 v[124:127], a[60:63], a[28:31], v[124:127]
    s_waitcnt lgkmcnt(0)
    v_mfma_f32_16x16x32_bf16 v[128:131], a[64:67], a[0:3], v[128:131]
    ds_read_b64_tr_b16 a[16:17], v8 offset:17120
    ds_read_b64_tr_b16 a[18:19], v8 offset:17376
    v_mfma_f32_16x16x32_bf16 v[132:135], a[68:71], a[0:3], v[132:135]
    ds_read_b64_tr_b16 a[20:21], v8 offset:34016
    ds_read_b64_tr_b16 a[22:23], v8 offset:34272
    v_mfma_f32_16x16x32_bf16 v[136:139], a[72:75], a[0:3], v[136:139]
    ds_read_b64_tr_b16 a[24:25], v9 offset:224
    ds_read_b64_tr_b16 a[26:27], v9 offset:480
    v_mfma_f32_16x16x32_bf16 v[140:143], a[76:79], a[0:3], v[140:143]
    ds_read_b64_tr_b16 a[28:29], v9 offset:17120
    ds_read_b64_tr_b16 a[30:31], v9 offset:17376
    v_mfma_f32_16x16x32_bf16 v[128:131], a[80:83], a[4:7], v[128:131]
    v_cvt_pk_bf16_f32 v112, v112, v113
    v_cvt_pk_bf16_f32 v113, v114, v115
    v_mfma_f32_16x16x32_bf16 v[132:135], a[84:87], a[4:7], v[132:135]
    v_cvt_pk_bf16_f32 v114, v116, v117
    v_cvt_pk_bf16_f32 v115, v118, v119
    v_mfma_f32_16x16x32_bf16 v[136:139], a[88:91], a[4:7], v[136:139]
    s_nop 1
    v_permlane32_swap_b32 v112, v114
    v_mfma_f32_16x16x32_bf16 v[140:143], a[92:95], a[4:7], v[140:143]
    v_permlane32_swap_b32 v113, v115
    s_nop 0
    v_mfma_f32_16x16x32_bf16 v[128:131], a[32:35], a[8:11], v[128:131]
    buffer_store_dwordx4 v[112:115], v14, s[28:31], s36 offen offset:1280 sc1
    v_cvt_pk_bf16_f32 v120, v120, v121
    v_mfma_f32_16x16x32_bf16 v[132:135], a[36:39], a[8:11], v[132:135]
    v_cvt_pk_bf16_f32 v121, v122, v123
    v_cvt_pk_bf16_f32 v122, v124, v125
    v_mfma_f32_16x16x32_bf16 v[136:139], a[40:43], a[8:11], v[136:139]
    v_cvt_pk_bf16_f32 v123, v126, v127
    s_nop 1
    v_mfma_f32_16x16x32_bf16 v[140:143], a[44:47], a[8:11], v[140:143]
    v_permlane32_swap_b32 v120, v122
    v_permlane32_swap_b32 v121, v123
    v_mfma_f32_16x16x32_bf16 v[128:131], a[48:51], a[12:15], v[128:131]
    s_nop 0
    buffer_store_dwordx4 v[120:123], v14, s[28:31], s38 offen offset:1280 sc1
    v_mfma_f32_16x16x32_bf16 v[132:135], a[52:55], a[12:15], v[132:135]
    v_mfma_f32_16x16x32_bf16 v[136:139], a[56:59], a[12:15], v[136:139]
    v_mfma_f32_16x16x32_bf16 v[140:143], a[60:63], a[12:15], v[140:143]
    s_waitcnt lgkmcnt(0)
    v_mfma_f32_16x16x32_bf16 v[144:147], a[64:67], a[16:19], v[144:147]
    s_nop 3
    s_nop 3
    v_mfma_f32_16x16x32_bf16 v[148:151], a[68:71], a[16:19], v[148:151]
    v_cvt_pk_bf16_f32 v128, v128, v129
    v_cvt_pk_bf16_f32 v129, v130, v131
    v_mfma_f32_16x16x32_bf16 v[152:155], a[72:75], a[16:19], v[152:155]
    v_cvt_pk_bf16_f32 v130, v132, v133
    v_cvt_pk_bf16_f32 v131, v134, v135
    v_mfma_f32_16x16x32_bf16 v[156:159], a[76:79], a[16:19], v[156:159]
    s_nop 1
    v_permlane32_swap_b32 v128, v130
    v_mfma_f32_16x16x32_bf16 v[144:147], a[80:83], a[20:23], v[144:147]
    v_permlane32_swap_b32 v129, v131
    s_nop 0
    v_mfma_f32_16x16x32_bf16 v[148:151], a[84:87], a[20:23], v[148:151]
    buffer_store_dwordx4 v[128:131], v14, s[28:31], s36 offen offset:1536 sc1
    v_cvt_pk_bf16_f32 v136, v136, v137
    v_mfma_f32_16x16x32_bf16 v[152:155], a[88:91], a[20:23], v[152:155]
    v_cvt_pk_bf16_f32 v137, v138, v139
    v_cvt_pk_bf16_f32 v138, v140, v141
    v_mfma_f32_16x16x32_bf16 v[156:159], a[92:95], a[20:23], v[156:159]
    v_cvt_pk_bf16_f32 v139, v142, v143
    s_nop 1
    v_mfma_f32_16x16x32_bf16 v[144:147], a[32:35], a[24:27], v[144:147]
    v_permlane32_swap_b32 v136, v138
    v_permlane32_swap_b32 v137, v139
    v_mfma_f32_16x16x32_bf16 v[148:151], a[36:39], a[24:27], v[148:151]
    s_nop 0
    buffer_store_dwordx4 v[136:139], v14, s[28:31], s38 offen offset:1536 sc1
    v_mfma_f32_16x16x32_bf16 v[152:155], a[40:43], a[24:27], v[152:155]
    v_mfma_f32_16x16x32_bf16 v[156:159], a[44:47], a[24:27], v[156:159]
    v_mfma_f32_16x16x32_bf16 v[144:147], a[48:51], a[28:31], v[144:147]
    v_mfma_f32_16x16x32_bf16 v[148:151], a[52:55], a[28:31], v[148:151]
    v_mfma_f32_16x16x32_bf16 v[152:155], a[56:59], a[28:31], v[152:155]
    v_mfma_f32_16x16x32_bf16 v[156:159], a[60:63], a[28:31], v[156:159]
    s_nop 7
    s_nop 3
    s_nop 3
    v_cvt_pk_bf16_f32 v144, v144, v145
    v_cvt_pk_bf16_f32 v145, v146, v147
    v_cvt_pk_bf16_f32 v146, v148, v149
    v_cvt_pk_bf16_f32 v147, v150, v151
    s_nop 1
    v_permlane32_swap_b32 v144, v146
    v_permlane32_swap_b32 v145, v147
    s_nop 0
    buffer_store_dwordx4 v[144:147], v14, s[28:31], s36 offen offset:1792 sc1
    v_cvt_pk_bf16_f32 v152, v152, v153
    v_cvt_pk_bf16_f32 v153, v154, v155
    v_cvt_pk_bf16_f32 v154, v156, v157
    v_cvt_pk_bf16_f32 v155, v158, v159
    s_nop 1
    v_permlane32_swap_b32 v152, v154
    v_permlane32_swap_b32 v153, v155
    s_nop 0
    buffer_store_dwordx4 v[152:155], v14, s[28:31], s38 offen offset:1792 sc1
    s_endpgm
K1_SIDE:
    s_load_dwordx2 s[46:47], s[0:1], 16
    s_load_dwordx4 s[12:15], s[0:1], 40
    s_sub_u32 s16, s2, 240
    s_lshl_b32 s16, s16, 3
    s_add_u32 s16, s16, s19
    v_lshlrev_b32 v2, 2, v1
    v_lshlrev_b32 v5, 4, v1
    v_lshrrev_b32 v3, 3, v1
    v_and_b32 v4, 7, v1
    v_mul_u32_u24 v3, 1280, v3
    v_lshl_add_u32 v3, v4, 4, v3
    v_lshrrev_b32 v4, 4, v1
    v_bfe_u32 v6, v1, 2, 2
    v_lshl_add_u32 v4, v4, 3, v6
    v_and_b32 v6, 3, v1
    v_lshlrev_b32 v6, 3, v6
    v_lshl_add_u32 v6, v4, 7, v6
    s_lshl_b32 s40, s19, 14
    v_add_u32 v6, s40, v6
    v_mov_b32 v4, 0
    s_waitcnt lgkmcnt(0)

    s_mov_b32 s20, s4
    s_mov_b32 s21, s5
    s_mov_b32 s22, 2621440
    s_mov_b32 s23, 0x00020000
    s_mov_b32 s28, s10
    s_mov_b32 s29, s11
    s_mov_b32 s30, 33554432
    s_mov_b32 s31, 0x00020000
    s_mov_b32 s32, s14
    s_mov_b32 s33, s15
    s_mov_b32 s34, 1280
    s_mov_b32 s35, 0x00020000
    v_and_b32 v7, 255, v0
    v_lshlrev_b32 v7, 7, v7
    s_mov_b32 s3, 29425664
    v_mov_b32 v24, 0
    v_mov_b32 v25, 0
    v_mov_b32 v26, 0
    v_mov_b32 v27, 0
    buffer_store_dwordx4 v[24:27], v7, s[28:31], s3 offen

    s_mov_b32 s38, 819200
    s_mov_b32 s39, 0x00020000
    s_load_dwordx2 s[50:51], s[0:1], 56
    v_lshlrev_b32 v29, 16, v0
    buffer_load_dword v28, v29, s[28:31], 0 offen
    s_waitcnt lgkmcnt(0)
    s_mov_b32 s56, s50
    s_mov_b32 s57, s51
    s_mov_b32 s58, 2621440
    s_mov_b32 s59, 0x00020000
    buffer_load_dword v28, v29, s[56:59], 0 offen
    s_add_u32 s41, s16, 0
    s_cmp_ge_u32 s41, 200
    s_cselect_b32 s36, s12, s46
    s_cselect_b32 s37, s13, s47
    s_cselect_b32 s3, 200, 0
    s_cselect_b32 s42, 819200, 0
    s_add_u32 s42, s42, 25165824
    s_sub_u32 s3, s41, s3
    s_mul_i32 s17, s3, 6554
    s_lshr_b32 s17, s17, 16
    s_mul_i32 s18, s17, 10
    s_sub_u32 s18, s3, s18
    s_lshl_b32 s3, s17, 10
    s_add_u32 s42, s42, s3
    s_mul_i32 s3, s18, 81920
    s_add_u32 s42, s42, s3
    s_mul_i32 s17, s17, 40960
    s_lshl_b32 s18, s18, 7
    s_add_u32 s17, s17, s18
    s_cmp_ge_u32 s41, 400
    s_cselect_b32 s42, 0x7f000000, s42
    s_cselect_b32 s17, 0x7f000000, s17

    s_add_u32 m0, s40, 0
    s_nop 0
    buffer_load_dwordx4 v3, s[36:39], s17 offen lds
    s_add_u32 s17, s17, 10240
    s_add_u32 m0, s40, 1024
    s_nop 0
    buffer_load_dwordx4 v3, s[36:39], s17 offen lds
    s_add_u32 s17, s17, 10240
    s_add_u32 m0, s40, 2048
    s_nop 0
    buffer_load_dwordx4 v3, s[36:39], s17 offen lds
    s_add_u32 s17, s17, 10240
    s_add_u32 m0, s40, 3072
    s_nop 0
    buffer_load_dwordx4 v3, s[36:39], s17 offen lds
    s_add_u32 s17, s17, 10240
    s_add_u32 s41, s16, 128
    s_cmp_ge_u32 s41, 200
    s_cselect_b32 s36, s12, s46
    s_cselect_b32 s37, s13, s47
    s_cselect_b32 s3, 200, 0
    s_cselect_b32 s43, 819200, 0
    s_add_u32 s43, s43, 25165824
    s_sub_u32 s3, s41, s3
    s_mul_i32 s17, s3, 6554
    s_lshr_b32 s17, s17, 16
    s_mul_i32 s18, s17, 10
    s_sub_u32 s18, s3, s18
    s_lshl_b32 s3, s17, 10
    s_add_u32 s43, s43, s3
    s_mul_i32 s3, s18, 81920
    s_add_u32 s43, s43, s3
    s_mul_i32 s17, s17, 40960
    s_lshl_b32 s18, s18, 7
    s_add_u32 s17, s17, s18
    s_cmp_ge_u32 s41, 400
    s_cselect_b32 s43, 0x7f000000, s43
    s_cselect_b32 s17, 0x7f000000, s17

    s_add_u32 m0, s40, 4096
    s_nop 0
    buffer_load_dwordx4 v3, s[36:39], s17 offen lds
    s_add_u32 s17, s17, 10240
    s_add_u32 m0, s40, 5120
    s_nop 0
    buffer_load_dwordx4 v3, s[36:39], s17 offen lds
    s_add_u32 s17, s17, 10240
    s_add_u32 m0, s40, 6144
    s_nop 0
    buffer_load_dwordx4 v3, s[36:39], s17 offen lds
    s_add_u32 s17, s17, 10240
    s_add_u32 m0, s40, 7168
    s_nop 0
    buffer_load_dwordx4 v3, s[36:39], s17 offen lds
    s_add_u32 s17, s17, 10240
    s_add_u32 s41, s16, 256
    s_cmp_ge_u32 s41, 200
    s_cselect_b32 s36, s12, s46
    s_cselect_b32 s37, s13, s47
    s_cselect_b32 s3, 200, 0
    s_cselect_b32 s44, 819200, 0
    s_add_u32 s44, s44, 25165824
    s_sub_u32 s3, s41, s3
    s_mul_i32 s17, s3, 6554
    s_lshr_b32 s17, s17, 16
    s_mul_i32 s18, s17, 10
    s_sub_u32 s18, s3, s18
    s_lshl_b32 s3, s17, 10
    s_add_u32 s44, s44, s3
    s_mul_i32 s3, s18, 81920
    s_add_u32 s44, s44, s3
    s_mul_i32 s17, s17, 40960
    s_lshl_b32 s18, s18, 7
    s_add_u32 s17, s17, s18
    s_cmp_ge_u32 s41, 400
    s_cselect_b32 s44, 0x7f000000, s44
    s_cselect_b32 s17, 0x7f000000, s17

    s_add_u32 m0, s40, 8192
    s_nop 0
    buffer_load_dwordx4 v3, s[36:39], s17 offen lds
    s_add_u32 s17, s17, 10240
    s_add_u32 m0, s40, 9216
    s_nop 0
    buffer_load_dwordx4 v3, s[36:39], s17 offen lds
    s_add_u32 s17, s17, 10240
    s_add_u32 m0, s40, 10240
    s_nop 0
    buffer_load_dwordx4 v3, s[36:39], s17 offen lds
    s_add_u32 s17, s17, 10240
    s_add_u32 m0, s40, 11264
    s_nop 0
    buffer_load_dwordx4 v3, s[36:39], s17 offen lds
    s_add_u32 s17, s17, 10240
    s_add_u32 s41, s16, 384
    s_cmp_ge_u32 s41, 200
    s_cselect_b32 s36, s12, s46
    s_cselect_b32 s37, s13, s47
    s_cselect_b32 s3, 200, 0
    s_cselect_b32 s45, 819200, 0
    s_add_u32 s45, s45, 25165824
    s_sub_u32 s3, s41, s3
    s_mul_i32 s17, s3, 6554
    s_lshr_b32 s17, s17, 16
    s_mul_i32 s18, s17, 10
    s_sub_u32 s18, s3, s18
    s_lshl_b32 s3, s17, 10
    s_add_u32 s45, s45, s3
    s_mul_i32 s3, s18, 81920
    s_add_u32 s45, s45, s3
    s_mul_i32 s17, s17, 40960
    s_lshl_b32 s18, s18, 7
    s_add_u32 s17, s17, s18
    s_cmp_ge_u32 s41, 400
    s_cselect_b32 s45, 0x7f000000, s45
    s_cselect_b32 s17, 0x7f000000, s17

    s_add_u32 m0, s40, 12288
    s_nop 0
    buffer_load_dwordx4 v3, s[36:39], s17 offen lds
    s_add_u32 s17, s17, 10240
    s_add_u32 m0, s40, 13312
    s_nop 0
    buffer_load_dwordx4 v3, s[36:39], s17 offen lds
    s_add_u32 s17, s17, 10240
    s_add_u32 m0, s40, 14336
    s_nop 0
    buffer_load_dwordx4 v3, s[36:39], s17 offen lds
    s_add_u32 s17, s17, 10240
    s_add_u32 m0, s40, 15360
    s_nop 0
    buffer_load_dwordx4 v3, s[36:39], s17 offen lds
    s_add_u32 s17, s17, 10240
    s_waitcnt vmcnt(12)
    ds_read_b64_tr_b16 v[72:73], v6 offset:0
    ds_read_b64_tr_b16 v[74:75], v6 offset:512
    ds_read_b64_tr_b16 v[76:77], v6 offset:32
    ds_read_b64_tr_b16 v[78:79], v6 offset:544
    ds_read_b64_tr_b16 v[80:81], v6 offset:64
    ds_read_b64_tr_b16 v[82:83], v6 offset:576
    ds_read_b64_tr_b16 v[84:85], v6 offset:96
    ds_read_b64_tr_b16 v[86:87], v6 offset:608
    s_waitcnt lgkmcnt(0)
    buffer_store_dwordx4 v[72:75], v5, s[28:31], s42 offen sc1
    s_add_u32 s42, s42, 20480
    buffer_store_dwordx4 v[76:79], v5, s[28:31], s42 offen sc1
    s_add_u32 s42, s42, 20480
    buffer_store_dwordx4 v[80:83], v5, s[28:31], s42 offen sc1
    s_add_u32 s42, s42, 20480
    buffer_store_dwordx4 v[84:87], v5, s[28:31], s42 offen sc1
    s_add_u32 s42, s42, 20480
    s_waitcnt vmcnt(12)
    ds_read_b64_tr_b16 v[88:89], v6 offset:4096
    ds_read_b64_tr_b16 v[90:91], v6 offset:4608
    ds_read_b64_tr_b16 v[92:93], v6 offset:4128
    ds_read_b64_tr_b16 v[94:95], v6 offset:4640
    ds_read_b64_tr_b16 v[96:97], v6 offset:4160
    ds_read_b64_tr_b16 v[98:99], v6 offset:4672
    ds_read_b64_tr_b16 v[100:101], v6 offset:4192
    ds_read_b64_tr_b16 v[102:103], v6 offset:4704
    s_waitcnt lgkmcnt(0)
    buffer_store_dwordx4 v[88:91], v5, s[28:31], s43 offen sc1
    s_add_u32 s43, s43, 20480
    buffer_store_dwordx4 v[92:95], v5, s[28:31], s43 offen sc1
    s_add_u32 s43, s43, 20480
    buffer_store_dwordx4 v[96:99], v5, s[28:31], s43 offen sc1
    s_add_u32 s43, s43, 20480
    buffer_store_dwordx4 v[100:103], v5, s[28:31], s43 offen sc1
    s_add_u32 s43, s43, 20480
    s_waitcnt vmcnt(12)
    ds_read_b64_tr_b16 v[104:105], v6 offset:8192
    ds_read_b64_tr_b16 v[106:107], v6 offset:8704
    ds_read_b64_tr_b16 v[108:109], v6 offset:8224
    ds_read_b64_tr_b16 v[110:111], v6 offset:8736
    ds_read_b64_tr_b16 v[112:113], v6 offset:8256
    ds_read_b64_tr_b16 v[114:115], v6 offset:8768
    ds_read_b64_tr_b16 v[116:117], v6 offset:8288
    ds_read_b64_tr_b16 v[118:119], v6 offset:8800
    s_waitcnt lgkmcnt(0)
    buffer_store_dwordx4 v[104:107], v5, s[28:31], s44 offen sc1
    s_add_u32 s44, s44, 20480
    buffer_store_dwordx4 v[108:111], v5, s[28:31], s44 offen sc1
    s_add_u32 s44, s44, 20480
    buffer_store_dwordx4 v[112:115], v5, s[28:31], s44 offen sc1
    s_add_u32 s44, s44, 20480
    buffer_store_dwordx4 v[116:119], v5, s[28:31], s44 offen sc1
    s_add_u32 s44, s44, 20480
    s_waitcnt vmcnt(12)
    ds_read_b64_tr_b16 v[120:121], v6 offset:12288
    ds_read_b64_tr_b16 v[122:123], v6 offset:12800
    ds_read_b64_tr_b16 v[124:125], v6 offset:12320
    ds_read_b64_tr_b16 v[126:127], v6 offset:12832
    ds_read_b64_tr_b16 v[128:129], v6 offset:12352
    ds_read_b64_tr_b16 v[130:131], v6 offset:12864
    ds_read_b64_tr_b16 v[132:133], v6 offset:12384
    ds_read_b64_tr_b16 v[134:135], v6 offset:12896
    s_waitcnt lgkmcnt(0)
    buffer_store_dwordx4 v[120:123], v5, s[28:31], s45 offen sc1
    s_add_u32 s45, s45, 20480
    buffer_store_dwordx4 v[124:127], v5, s[28:31], s45 offen sc1
    s_add_u32 s45, s45, 20480
    buffer_store_dwordx4 v[128:131], v5, s[28:31], s45 offen sc1
    s_add_u32 s45, s45, 20480
    buffer_store_dwordx4 v[132:135], v5, s[28:31], s45 offen sc1
    s_add_u32 s45, s45, 20480
    s_lshr_b32 s3, s16, 3
    s_lshl_b32 s3, s3, 7
    s_and_b32 s17, s16, 7
    s_add_u32 s3, s3, s17
    s_add_u32 s3, s3, 120
    s_and_b32 s17, s3, 1023
    s_mul_i32 s17, s17, 2560
    s_lshr_b32 s18, s3, 10
    s_mul_i32 s18, s18, 1280
    s_add_u32 s17, s17, s18
    s_lshl_b32 s18, s3, 2
    s_add_u32 s18, s18, 29360128

    buffer_load_dword v8, v2, s[32:35], 0 offen offset:0
    buffer_load_dword v9, v2, s[32:35], 0 offen offset:256
    buffer_load_dword v10, v2, s[32:35], 0 offen offset:512
    buffer_load_dword v11, v2, s[32:35], 0 offen offset:768
    buffer_load_dword v12, v2, s[32:35], 0 offen offset:1024
    buffer_load_dword v16, v2, s[20:23], s17 offen offset:0
    buffer_load_dword v17, v2, s[20:23], s17 offen offset:256
    buffer_load_dword v18, v2, s[20:23], s17 offen offset:512
    buffer_load_dword v19, v2, s[20:23], s17 offen offset:768
    buffer_load_dword v20, v2, s[20:23], s17 offen offset:1024
    s_waitcnt vmcnt(0)
    v_dot2_f32_bf16 v22, v16, v8, 0
    v_dot2_f32_bf16 v22, v17, v9, v22
    v_dot2_f32_bf16 v22, v18, v10, v22
    v_dot2_f32_bf16 v22, v19, v11, v22
    v_dot2_f32_bf16 v22, v20, v12, v22
    s_nop 3
    v_add_f32_dpp v22, v22, v22 row_shr:1 row_mask:0xf bank_mask:0xf bound_ctrl:0
    s_nop 1
    v_add_f32_dpp v22, v22, v22 row_shr:2 row_mask:0xf bank_mask:0xf bound_ctrl:0
    s_nop 1
    v_add_f32_dpp v22, v22, v22 row_shr:4 row_mask:0xf bank_mask:0xf bound_ctrl:0
    s_nop 1
    v_add_f32_dpp v22, v22, v22 row_shr:8 row_mask:0xf bank_mask:0xf bound_ctrl:0
    s_nop 1
    v_add_f32_dpp v22, v22, v22 row_bcast:15 row_mask:0xa bank_mask:0xf
    s_nop 1
    v_add_f32_dpp v22, v22, v22 row_bcast:31 row_mask:0xc bank_mask:0xf
    s_nop 1
    v_mul_f32 v22, 0xbfb8aa3b, v22
    v_exp_f32 v22, v22
    s_nop 0
    v_add_f32 v22, 1.0, v22
    v_rcp_f32 v22, v22
    s_mov_b32 exec_lo, 0
    s_mov_b32 exec_hi, 0x80000000
    buffer_store_dword v22, v4, s[28:31], s18 offen offset:0
    s_mov_b64 exec, -1
    s_getpc_b64 s[52:53]
CT_2115:
    s_add_u32 s52, s52, attn_kernel-CT_2115
    s_addc_u32 s53, s53, 0
    v_lshlrev_b32 v30, 7, v0
    v_min_u32 v30, CODE_END-attn_kernel-4, v30
    global_load_dword v31, v30, s[52:53]
K1_END:
    s_endpgm
.globl attn_kernel
.p2align 8
.type attn_kernel,@function
attn_kernel:
    s_cmp_ge_u32 s2, 512
    s_cbranch_scc1 K2_END
    s_load_dwordx2 s[10:11], s[0:1], 72
    v_lshrrev_b32 v8, 6, v0
    v_and_b32 v1, 63, v0
    s_and_b32 s14, s2, 7
    v_readfirstlane_b32 s19, v8
    s_cmp_ge_u32 s2, 256
    s_cbranch_scc1 K2_AROLE
    s_setprio 3
    s_lshr_b32 s15, s2, 3
    s_lshl_b32 s17, s14, 2
    s_lshr_b32 s3, s15, 3
    s_add_u32 s17, s17, s3
    s_and_b32 s9, s15, 7
    s_lshl_b32 s9, s9, 3
    s_add_u32 s18, s9, s19

    v_and_b32 v8, 31, v1
    v_lshrrev_b32 v9, 5, v1
    v_lshlrev_b32 v113, 4, v1
    s_and_b32 s4, s17, 1
    s_mul_i32 s5, s17, 5
    s_lshr_b32 s5, s5, 1
    s_lshl_b32 s5, s5, 9
    s_lshl_b32 s6, s4, 9
    s_cmp_eq_u32 s4, 0
    s_cselect_b32 s7, 1024, 8
    v_add_u32 v2, s6, v113
    v_lshl_add_u32 v3, v8, 4, s7
    v_add_u32 v31, s5, v2
    v_add_u32 v112, s5, v3
    s_mul_i32 s6, s17, 320
    s_mul_i32 s21, s18, 40960

    s_add_u32 s5, s5, 10485760
    v_add_u32 v22, s5, v113
    s_add_u32 s7, s6, 13105664
    v_cmp_le_u32 s[36:37], 54, v1
    v_mov_b32 v12, 9888
    v_add_u32 v13, s7, v113
    v_cndmask_b32 v12, 0, v12, s[36:37]
    v_add_u32 v13, v13, v12
    v_cmp_le_u32 s[36:37], 32, v1
    v_add_u32 v11, 32, v1
    v_mul_u32_u24 v11, 47, v11
    v_cndmask_b32 v23, v22, v13, s[36:37]
    v_lshrrev_b32 v11, 10, v11
    v_mul_u32_u24 v11, 9888, v11
    s_add_u32 s7, s6, 13105664
    v_add3_u32 v30, v11, v113, s7
    s_add_u32 s8, s21, 7864320
    s_waitcnt lgkmcnt(0)

    s_mov_b32 s28, s10
    s_mov_b32 s29, s11
    s_mov_b32 s30, 33554432
    s_mov_b32 s31, 0x00020000
    s_mul_i32 s24, s19, 40960
    s_mul_i32 s25, s19, 2944
    s_mov_b32 m0, s25
    s_add_u32 s25, s25, 23552
    buffer_load_dwordx4 v22, s[28:31], s24 offen lds
    s_mov_b32 exec_hi, 0xffcfffff
    buffer_load_dwordx4 v23, s[28:31], s24 offen offset:1024 lds
    s_mov_b32 exec_hi, -1
    s_mov_b32 exec_lo, 0xfffff3ff
    s_mov_b32 exec_hi, 0x003ffffc
    buffer_load_dwordx4 v30, s[28:31], s24 offen offset:2048 lds
    s_mov_b64 exec, -1
    s_add_u32 s24, s24, 327680
    s_cmp_ge_u32 s24, 2621440
    s_cselect_b32 s24, 0x40000000, s24
    s_cmp_ge_u32 s25, 70656
    s_cselect_b32 s36, 70656, 0
    s_sub_u32 s25, s25, s36
    buffer_load_dwordx4 v[16:19], v31, s[28:31], s8 offen
    buffer_load_dwordx2 v[20:21], v112, s[28:31], s8 offen
    s_mov_b32 s20, 0
    v_mov_b32 v32, 0x3f803f80
    v_mov_b32 v33, 0x3f803f80
    v_mov_b32 v34, 0x3f803f80
    v_mov_b32 v35, 0x3f803f80
    v_bfe_u32 v11, v1, 2, 2
    v_min_u32 v11, 2, v11
    v_mul_u32_u24 v11, 23552, v11
    v_and_b32 v12, 3, v1
    v_mul_u32_u24 v12, 352, v12
    s_mul_i32 s3, s19, 2944
    v_add3_u32 v11, v11, v12, s3
    ds_write_b128 v11, v[32:35] offset:1856
    v_mov_b32 v12, 0
    v_mov_b32 v13, 0
    ds_write_b64 v11, v[12:13] offset:1872
    ds_write_b64 v11, v[12:13] offset:1880
    v_mov_b32 v11, 70912
    ds_write_b32 v11, v12

    s_lshl_b32 s5, s4, 2
    v_add_u32 v12, s5, v8
    v_subrev_u32 v13, 20, v12
    v_cmp_gt_u32 s[36:37], 20, v12
    v_cmp_gt_u32 s[38:39], 20, v8
    v_and_b32 v10, 3, v8
    v_cndmask_b32 v12, v13, v12, s[36:37]
    v_cndmask_b32 v12, v8, v12, s[38:39]
    v_bfe_u32 v11, v8, 2, 1
    v_lshl_or_b32 v10, v11, 3, v10
    v_bfe_u32 v11, v8, 3, 1
    v_lshl_or_b32 v10, v11, 2, v10
    v_lshrrev_b32 v11, 4, v8
    v_lshl_or_b32 v14, v11, 4, v10
    v_lshlrev_b32 v10, 4, v10
    v_mul_u32_u24 v11, 20480, v11
    s_mul_i32 s3, s17, 5
    s_add_u32 s3, s3, 1
    s_lshr_b32 s3, s3, 1
    s_lshl_b32 s3, s3, 8
    v_add3_u32 v10, v10, v11, s3
    v_lshl_add_u32 v15, v9, 8, v10
    s_mul_i32 s5, s4, 760
    s_sub_u32 s5, 512, s5
    v_add_u32 v114, s5, v10
    s_add_u32 s22, s21, 19398656
    v_lshlrev_b32 v122, 2, v14
    s_lshl_b32 s23, s18, 7
    s_add_u32 s23, s23, 29360128

    buffer_load_dword v122, v122, s[28:31], s23 offen
    v_mul_u32_u24 v11, 352, v9
    v_min_u32 v12, 21, v12
    v_lshl_add_u32 v11, v12, 4, v11
    v_add_u32 v4, 1536, v11
    s_mov_b32 exec_lo, 0
    v_mov_b32 v3, 1872
    s_mov_b32 exec_lo, -1

    s_mov_b32 m0, s25
    s_add_u32 s25, s25, 23552
    buffer_load_dwordx4 v22, s[28:31], s24 offen lds
    s_mov_b32 exec_hi, 0xffcfffff
    buffer_load_dwordx4 v23, s[28:31], s24 offen offset:1024 lds
    s_mov_b32 exec_hi, -1
    s_mov_b32 exec_lo, 0xfffff3ff
    s_mov_b32 exec_hi, 0x003ffffc
    buffer_load_dwordx4 v30, s[28:31], s24 offen offset:2048 lds
    s_mov_b64 exec, -1
    s_add_u32 s24, s24, 327680
    s_cmp_ge_u32 s24, 2621440
    s_cselect_b32 s24, 0x40000000, s24
    s_cmp_ge_u32 s25, 70656
    s_cselect_b32 s36, 70656, 0
    s_sub_u32 s25, s25, s36
    v_mov_b32 v96, 0
    v_mov_b32 v97, 0
    v_mov_b32 v98, 0
    v_mov_b32 v99, 0
    v_mov_b32 v100, 0
    v_mov_b32 v101, 0
    v_mov_b32 v102, 0
    v_mov_b32 v103, 0
    v_mov_b32 v104, 0
    v_mov_b32 v105, 0
    v_mov_b32 v106, 0
    v_mov_b32 v107, 0
    v_mov_b32 v108, 0
    v_mov_b32 v109, 0
    v_mov_b32 v110, 0
    v_mov_b32 v111, 0
    v_mov_b32 v44, 0
    v_mov_b32 v36, 0
    v_mov_b32 v45, 0
    v_mov_b32 v37, 0
    v_mov_b32 v46, 0
    v_mov_b32 v38, 0
    v_mov_b32 v47, 0
    v_mov_b32 v39, 0
    v_mov_b32 v7, v4
    v_mov_b32 v5, v2
    v_mov_b32 v6, v3
    s_mov_b32 s26, 23552
    s_mov_b32 s27, 0

    v_mov_b32 v123, 29425664
    v_mov_b32 v124, 1
    v_mov_b32 v116, -1
    v_mov_b32 v117, -1
    v_mov_b32 v118, -1
    v_mov_b32 v119, -1
    s_lshl_b32 s46, s2, 7
    s_cmp_eq_u32 s19, 7
    s_cselect_b32 s46, s46, 0x40000000
    s_cselect_b32 s47, 0, 0x40000000
    s_lshl_b32 s3, s9, 4
    s_add_u32 s47, s47, s3
    s_add_u32 s47, s47, 29425668
    v_lshlrev_b32 v125, 10, v1
    s_waitcnt vmcnt(3) lgkmcnt(0)

    s_barrier
    ds_read_b128 v[24:27], v5 offset:0
    ds_read_b64 v[28:29], v6 offset:0
    s_mov_b32 exec_lo, 0
    v_mov_b32 v20, 0
    v_mov_b32 v21, 0
    s_mov_b32 exec_lo, -1
    v_sub_f32 v122, 1.0, v122
    s_waitcnt lgkmcnt(0)

    v_mfma_f32_32x32x16_bf16 v[64:79], v[24:27], v[16:19], 0
    v_mfma_f32_32x32x8_bf16 v[64:79], v[28:29], v[20:21], v[64:79]
    s_nop 11
    v_max3_f32 v8, v64, v65, v66
    v_max3_f32 v8, v8, v67, v68
    v_max3_f32 v8, v8, v69, v70
    v_max3_f32 v8, v8, v71, v72
    v_max3_f32 v8, v8, v73, v74
    v_max3_f32 v8, v8, v75, v76
    v_max3_f32 v8, v8, v77, v78
    v_max_f32 v8, v8, v79
    v_mov_b32 v9, v8
    s_nop 1
    v_permlane32_swap_b32 v8, v9
    s_nop 1
    v_max_f32 v8, v8, v9
    v_sub_f32 v48, 0, v8
    v_sub_f32 v49, 0, v8
    v_sub_f32 v50, 0, v8
    v_sub_f32 v51, 0, v8
    v_sub_f32 v52, 0, v8
    v_sub_f32 v53, 0, v8
    v_sub_f32 v54, 0, v8
    v_sub_f32 v55, 0, v8
    v_sub_f32 v56, 0, v8
    v_sub_f32 v57, 0, v8
    v_sub_f32 v58, 0, v8
    v_sub_f32 v59, 0, v8
    v_sub_f32 v60, 0, v8
    v_sub_f32 v61, 0, v8
    v_sub_f32 v62, 0, v8
    v_sub_f32 v63, 0, v8
K2_HAVE_M:
    s_waitcnt lgkmcnt(0)
    s_nop 0
    v_mfma_f32_32x32x16_bf16 v[64:79], v[24:27], v[16:19], v[48:63]
    v_mfma_f32_32x32x8_bf16 v[64:79], v[28:29], v[20:21], v[64:79]
    ds_read_b128 v[24:27], v5 offset:2944
    ds_read_b64 v[28:29], v6 offset:2944
    ds_read_b128 v[32:35], v7 offset:0
    s_nop 9
.p2align 3
K2_LOOP:
    v_exp_f32 v64, v64
    v_exp_f32 v65, v65
    v_mfma_f32_32x32x16_bf16 v[96:111], v[36:39], v[44:47], v[96:111]
    ds_read_b128 v[36:39], v7 offset:704
    v_exp_f32 v66, v66
    v_exp_f32 v67, v67
    v_cvt_pk_bf16_f32 v40, v64, v65
    v_exp_f32 v68, v68
    v_cvt_pk_bf16_f32 v41, v66, v67
    s_waitcnt lgkmcnt(1)
    v_mfma_f32_32x32x16_bf16 v[80:95], v[24:27], v[16:19], v[48:63]
    v_exp_f32 v69, v69
    v_exp_f32 v70, v70
    v_exp_f32 v71, v71
    v_cvt_pk_bf16_f32 v42, v68, v69
    v_exp_f32 v72, v72
    v_cvt_pk_bf16_f32 v43, v70, v71
    v_mfma_f32_32x32x8_bf16 v[80:95], v[28:29], v[20:21], v[80:95]
    ds_read_b128 v[24:27], v5 offset:5888
    ds_read_b64 v[28:29], v6 offset:5888
    v_exp_f32 v73, v73
    v_exp_f32 v74, v74
    v_exp_f32 v75, v75
    v_cvt_pk_bf16_f32 v44, v72, v73
    v_exp_f32 v76, v76
    v_cvt_pk_bf16_f32 v45, v74, v75
    v_mfma_f32_32x32x16_bf16 v[96:111], v[32:35], v[40:43], v[96:111]
    ds_read_b128 v[32:35], v7 offset:2944
    v_exp_f32 v77, v77
    v_exp_f32 v78, v78
    v_exp_f32 v79, v79
    v_cvt_pk_bf16_f32 v46, v76, v77
    s_waitcnt lgkmcnt(3)
    v_cvt_pk_bf16_f32 v47, v78, v79
    s_setprio 2
    s_cmp_eq_u32 s27, 6
    s_cbranch_scc1 K2_SIG
    s_cmp_eq_u32 s27, 0
    s_cbranch_scc0 K2_NOSIG
    s_cmp_lg_u32 s20, 0
    s_cbranch_scc1 K2_NOSIG
    s_mov_b32 exec_hi, 0
    buffer_store_dwordx2 v[116:117], v114, s[28:31], s22 offen sc1
    s_mov_b32 exec_hi, -1
    buffer_store_dwordx4 v[116:119], v15, s[28:31], s22 offen sc1

K2_SIG:
    s_mov_b64 exec, 1
    buffer_atomic_add v124, v123, s[28:31], s46 offen sc1
    s_mov_b64 exec, -1

K2_NOSIG:
    v_exp_f32 v80, v80
    v_exp_f32 v81, v81
    v_mfma_f32_32x32x16_bf16 v[96:111], v[36:39], v[44:47], v[96:111]
    ds_read_b128 v[36:39], v7 offset:3648
    v_exp_f32 v82, v82
    v_exp_f32 v83, v83
    v_cvt_pk_bf16_f32 v40, v80, v81
    v_exp_f32 v84, v84
    v_cvt_pk_bf16_f32 v41, v82, v83
    s_waitcnt lgkmcnt(1)
    v_mfma_f32_32x32x16_bf16 v[64:79], v[24:27], v[16:19], v[48:63]
    v_exp_f32 v85, v85
    v_exp_f32 v86, v86
    v_exp_f32 v87, v87
    v_cvt_pk_bf16_f32 v42, v84, v85
    v_exp_f32 v88, v88
    v_cvt_pk_bf16_f32 v43, v86, v87
    v_mfma_f32_32x32x8_bf16 v[64:79], v[28:29], v[20:21], v[64:79]
    ds_read_b128 v[24:27], v5 offset:8832
    ds_read_b64 v[28:29], v6 offset:8832
    v_exp_f32 v89, v89
    v_exp_f32 v90, v90
    v_exp_f32 v91, v91
    v_cvt_pk_bf16_f32 v44, v88, v89
    v_exp_f32 v92, v92
    v_cvt_pk_bf16_f32 v45, v90, v91
    v_mfma_f32_32x32x16_bf16 v[96:111], v[32:35], v[40:43], v[96:111]
    ds_read_b128 v[32:35], v7 offset:5888
    v_exp_f32 v93, v93
    v_exp_f32 v94, v94
    v_exp_f32 v95, v95
    v_cvt_pk_bf16_f32 v46, v92, v93
    s_waitcnt lgkmcnt(3)
    v_cvt_pk_bf16_f32 v47, v94, v95
    v_exp_f32 v64, v64
    v_exp_f32 v65, v65
    v_mfma_f32_32x32x16_bf16 v[96:111], v[36:39], v[44:47], v[96:111]
    ds_read_b128 v[36:39], v7 offset:6592
    v_exp_f32 v66, v66
    v_exp_f32 v67, v67
    v_cvt_pk_bf16_f32 v40, v64, v65
    v_exp_f32 v68, v68
    v_cvt_pk_bf16_f32 v41, v66, v67
    s_waitcnt lgkmcnt(1)
    v_mfma_f32_32x32x16_bf16 v[80:95], v[24:27], v[16:19], v[48:63]
    v_exp_f32 v69, v69
    v_exp_f32 v70, v70
    v_exp_f32 v71, v71
    v_cvt_pk_bf16_f32 v42, v68, v69
    v_exp_f32 v72, v72
    v_cvt_pk_bf16_f32 v43, v70, v71
    v_mfma_f32_32x32x8_bf16 v[80:95], v[28:29], v[20:21], v[80:95]
    ds_read_b128 v[24:27], v5 offset:11776
    ds_read_b64 v[28:29], v6 offset:11776
    v_exp_f32 v73, v73
    v_exp_f32 v74, v74
    v_exp_f32 v75, v75
    v_cvt_pk_bf16_f32 v44, v72, v73
    v_exp_f32 v76, v76
    v_cvt_pk_bf16_f32 v45, v74, v75
    v_mfma_f32_32x32x16_bf16 v[96:111], v[32:35], v[40:43], v[96:111]
    ds_read_b128 v[32:35], v7 offset:8832
    v_exp_f32 v77, v77
    v_exp_f32 v78, v78
    v_exp_f32 v79, v79
    v_cvt_pk_bf16_f32 v46, v76, v77
    s_waitcnt lgkmcnt(3)
    v_cvt_pk_bf16_f32 v47, v78, v79
    s_setprio 1
    v_exp_f32 v80, v80
    v_exp_f32 v81, v81
    v_mfma_f32_32x32x16_bf16 v[96:111], v[36:39], v[44:47], v[96:111]
    ds_read_b128 v[36:39], v7 offset:9536
    v_exp_f32 v82, v82
    v_exp_f32 v83, v83
    v_cvt_pk_bf16_f32 v40, v80, v81
    v_exp_f32 v84, v84
    v_cvt_pk_bf16_f32 v41, v82, v83
    s_waitcnt lgkmcnt(1)
    v_mfma_f32_32x32x16_bf16 v[64:79], v[24:27], v[16:19], v[48:63]
    v_exp_f32 v85, v85
    v_exp_f32 v86, v86
    v_exp_f32 v87, v87
    v_cvt_pk_bf16_f32 v42, v84, v85
    v_exp_f32 v88, v88
    v_cvt_pk_bf16_f32 v43, v86, v87
    v_mfma_f32_32x32x8_bf16 v[64:79], v[28:29], v[20:21], v[64:79]
    ds_read_b128 v[24:27], v5 offset:14720
    ds_read_b64 v[28:29], v6 offset:14720
    v_exp_f32 v89, v89
    v_exp_f32 v90, v90
    v_exp_f32 v91, v91
    v_cvt_pk_bf16_f32 v44, v88, v89
    v_exp_f32 v92, v92
    v_cvt_pk_bf16_f32 v45, v90, v91
    v_mfma_f32_32x32x16_bf16 v[96:111], v[32:35], v[40:43], v[96:111]
    ds_read_b128 v[32:35], v7 offset:11776
    v_exp_f32 v93, v93
    v_exp_f32 v94, v94
    v_exp_f32 v95, v95
    v_cvt_pk_bf16_f32 v46, v92, v93
    s_waitcnt lgkmcnt(3)
    v_cvt_pk_bf16_f32 v47, v94, v95
    v_exp_f32 v64, v64
    v_exp_f32 v65, v65
    v_mfma_f32_32x32x16_bf16 v[96:111], v[36:39], v[44:47], v[96:111]
    ds_read_b128 v[36:39], v7 offset:12480
    v_exp_f32 v66, v66
    v_exp_f32 v67, v67
    v_cvt_pk_bf16_f32 v40, v64, v65
    v_exp_f32 v68, v68
    v_cvt_pk_bf16_f32 v41, v66, v67
    s_waitcnt lgkmcnt(1)
    v_mfma_f32_32x32x16_bf16 v[80:95], v[24:27], v[16:19], v[48:63]
    v_exp_f32 v69, v69
    v_exp_f32 v70, v70
    v_exp_f32 v71, v71
    v_cvt_pk_bf16_f32 v42, v68, v69
    v_exp_f32 v72, v72
    v_cvt_pk_bf16_f32 v43, v70, v71
    v_mfma_f32_32x32x8_bf16 v[80:95], v[28:29], v[20:21], v[80:95]
    ds_read_b128 v[24:27], v5 offset:17664
    ds_read_b64 v[28:29], v6 offset:17664
    v_exp_f32 v73, v73
    v_exp_f32 v74, v74
    v_exp_f32 v75, v75
    v_cvt_pk_bf16_f32 v44, v72, v73
    v_exp_f32 v76, v76
    v_cvt_pk_bf16_f32 v45, v74, v75
    v_mfma_f32_32x32x16_bf16 v[96:111], v[32:35], v[40:43], v[96:111]
    ds_read_b128 v[32:35], v7 offset:14720
    v_exp_f32 v77, v77
    v_exp_f32 v78, v78
    v_exp_f32 v79, v79
    v_cvt_pk_bf16_f32 v46, v76, v77
    s_waitcnt lgkmcnt(3)
    v_cvt_pk_bf16_f32 v47, v78, v79
    s_setprio 0
    v_exp_f32 v80, v80
    v_exp_f32 v81, v81
    v_mfma_f32_32x32x16_bf16 v[96:111], v[36:39], v[44:47], v[96:111]
    ds_read_b128 v[36:39], v7 offset:15424
    v_exp_f32 v82, v82
    v_exp_f32 v83, v83
    v_cvt_pk_bf16_f32 v40, v80, v81
    v_exp_f32 v84, v84
    v_cvt_pk_bf16_f32 v41, v82, v83
    s_waitcnt lgkmcnt(1)
    v_mfma_f32_32x32x16_bf16 v[64:79], v[24:27], v[16:19], v[48:63]
    v_exp_f32 v85, v85
    v_exp_f32 v86, v86
    v_exp_f32 v87, v87
    v_cvt_pk_bf16_f32 v42, v84, v85
    v_exp_f32 v88, v88
    v_cvt_pk_bf16_f32 v43, v86, v87
    v_mfma_f32_32x32x8_bf16 v[64:79], v[28:29], v[20:21], v[64:79]
    ds_read_b128 v[24:27], v5 offset:20608
    ds_read_b64 v[28:29], v6 offset:20608
    v_exp_f32 v89, v89
    v_exp_f32 v90, v90
    v_exp_f32 v91, v91
    v_cvt_pk_bf16_f32 v44, v88, v89
    v_exp_f32 v92, v92
    v_cvt_pk_bf16_f32 v45, v90, v91
    v_mfma_f32_32x32x16_bf16 v[96:111], v[32:35], v[40:43], v[96:111]
    ds_read_b128 v[32:35], v7 offset:17664
    v_exp_f32 v93, v93
    v_exp_f32 v94, v94
    v_exp_f32 v95, v95
    v_cvt_pk_bf16_f32 v46, v92, v93
    s_waitcnt lgkmcnt(3)
    v_cvt_pk_bf16_f32 v47, v94, v95
    s_waitcnt vmcnt(0)
    s_barrier
    v_add_u32 v5, s26, v2
    v_add_u32 v6, s26, v3
    s_setprio 3
    v_exp_f32 v64, v64
    v_exp_f32 v65, v65
    v_mfma_f32_32x32x16_bf16 v[96:111], v[36:39], v[44:47], v[96:111]
    ds_read_b128 v[36:39], v7 offset:18368
    v_exp_f32 v66, v66
    s_mov_b32 m0, s25
    s_add_u32 s25, s25, 23552
    buffer_load_dwordx4 v22, s[28:31], s24 offen lds
    v_exp_f32 v67, v67
    v_cvt_pk_bf16_f32 v40, v64, v65
    v_exp_f32 v68, v68
    v_cvt_pk_bf16_f32 v41, v66, v67
    s_waitcnt lgkmcnt(1)
    v_mfma_f32_32x32x16_bf16 v[80:95], v[24:27], v[16:19], v[48:63]
    v_exp_f32 v69, v69
    s_mov_b32 exec_hi, 0xffcfffff
    buffer_load_dwordx4 v23, s[28:31], s24 offen offset:1024 lds
    s_mov_b32 exec_hi, -1
    v_exp_f32 v70, v70
    v_exp_f32 v71, v71
    v_cvt_pk_bf16_f32 v42, v68, v69
    v_exp_f32 v72, v72
    v_cvt_pk_bf16_f32 v43, v70, v71
    v_mfma_f32_32x32x8_bf16 v[80:95], v[28:29], v[20:21], v[80:95]
    ds_read_b128 v[24:27], v5 offset:0
    ds_read_b64 v[28:29], v6 offset:0
    v_exp_f32 v73, v73
    s_mov_b32 exec_lo, 0xfffff3ff
    s_mov_b32 exec_hi, 0x003ffffc
    buffer_load_dwordx4 v30, s[28:31], s24 offen offset:2048 lds
    s_mov_b64 exec, -1
    v_exp_f32 v74, v74
    v_exp_f32 v75, v75
    v_cvt_pk_bf16_f32 v44, v72, v73
    v_exp_f32 v76, v76
    v_cvt_pk_bf16_f32 v45, v74, v75
    v_mfma_f32_32x32x16_bf16 v[96:111], v[32:35], v[40:43], v[96:111]
    ds_read_b128 v[32:35], v7 offset:20608
    v_exp_f32 v77, v77
    s_add_u32 s24, s24, 327680
    s_cmp_ge_u32 s24, 2621440
    s_cselect_b32 s24, 0x40000000, s24
    v_exp_f32 v78, v78
    s_cmp_ge_u32 s25, 70656
    s_cselect_b32 s36, 70656, 0
    s_sub_u32 s25, s25, s36
    v_exp_f32 v79, v79
    v_cvt_pk_bf16_f32 v46, v76, v77
    s_waitcnt lgkmcnt(3)
    v_cvt_pk_bf16_f32 v47, v78, v79
    s_cmp_eq_u32 s27, 7
    s_cbranch_scc0 K2_NOHINT
    s_mov_b32 exec_hi, 0
    buffer_atomic_add v124, v125, s[28:31], s47 offen sc1
    s_mov_b32 exec_hi, -1

K2_NOHINT:
    v_exp_f32 v80, v80
    v_exp_f32 v81, v81
    v_mfma_f32_32x32x16_bf16 v[96:111], v[36:39], v[44:47], v[96:111]
    ds_read_b128 v[36:39], v7 offset:21312
    v_exp_f32 v82, v82
    v_exp_f32 v83, v83
    v_cvt_pk_bf16_f32 v40, v80, v81
    v_exp_f32 v84, v84
    v_cvt_pk_bf16_f32 v41, v82, v83
    s_waitcnt lgkmcnt(1)
    v_mfma_f32_32x32x16_bf16 v[64:79], v[24:27], v[16:19], v[48:63]
    v_exp_f32 v85, v85
    v_exp_f32 v86, v86
    v_exp_f32 v87, v87
    v_cvt_pk_bf16_f32 v42, v84, v85
    v_exp_f32 v88, v88
    v_cvt_pk_bf16_f32 v43, v86, v87
    v_mfma_f32_32x32x8_bf16 v[64:79], v[28:29], v[20:21], v[64:79]
    ds_read_b128 v[24:27], v5 offset:2944
    ds_read_b64 v[28:29], v6 offset:2944
    v_exp_f32 v89, v89
    v_exp_f32 v90, v90
    v_exp_f32 v91, v91
    v_cvt_pk_bf16_f32 v44, v88, v89
    v_exp_f32 v92, v92
    v_cvt_pk_bf16_f32 v45, v90, v91
    v_add_u32 v7, s26, v4
    v_mfma_f32_32x32x16_bf16 v[96:111], v[32:35], v[40:43], v[96:111]
    ds_read_b128 v[32:35], v7 offset:0
    v_exp_f32 v93, v93
    v_exp_f32 v94, v94
    v_exp_f32 v95, v95
    v_cvt_pk_bf16_f32 v46, v92, v93
    s_waitcnt lgkmcnt(3)
    v_cvt_pk_bf16_f32 v47, v94, v95
    s_add_u32 s26, s26, 23552
    s_cmp_ge_u32 s26, 70656
    s_cselect_b32 s26, 0, s26
    s_add_u32 s27, s27, 1
    s_cmp_lt_u32 s27, 8
    s_cbranch_scc1 K2_LOOP
    v_mfma_f32_32x32x16_bf16 v[96:111], v[36:39], v[44:47], v[96:111]

    v_mov_b32 v11, 70912
    s_mov_b32 s3, 0x71800000
    s_waitcnt lgkmcnt(0)
    s_nop 9

    v_mov_b32 v10, v104
    s_mov_b32 exec_hi, 0
    v_mul_f32 v10, 0, v104
    v_fma_f32 v10, v105, 0, v10
    v_fma_f32 v10, v106, 0, v10
    v_fma_f32 v10, v107, 0, v10
    s_mov_b32 exec_hi, -1
    v_fma_f32 v10, v96, 0, v10
    v_fma_f32 v10, v97, 0, v10
    v_fma_f32 v10, v98, 0, v10
    v_fma_f32 v10, v99, 0, v10
    v_fma_f32 v10, v100, 0, v10
    v_fma_f32 v10, v101, 0, v10
    v_fma_f32 v10, v102, 0, v10
    v_fma_f32 v10, v103, 0, v10
    v_cmp_nlt_f32 s[36:37], v10, s3
    s_nop 3
    s_cmp_eq_u32 s20, 0
    s_cbranch_scc1 K2_FIRST
    s_cmp_eq_u32 s48, 0
    s_cbranch_scc1 K2_NOFLAG
    s_branch K2_GOOD

K2_FIRST:
    s_cmp_eq_u64 s[36:37], 0
    s_cselect_b32 s48, 0, 1
    s_cbranch_scc1 K2_GOOD
    ds_write_b32 v11, v124
    s_branch K2_NOFLAG

K2_GOOD:
    v_mov_b32 v8, v104
    v_mov_b32 v9, v104
    s_nop 1
    v_permlane32_swap_b32 v8, v9
    s_nop 1
    v_rcp_f32 v8, v9
    s_nop 0
    v_mul_f32 v8, v8, v122

    v_mul_f32 v96, v96, v8
    v_mul_f32 v97, v97, v8
    v_mul_f32 v98, v98, v8
    v_mul_f32 v99, v99, v8
    v_mul_f32 v100, v100, v8
    v_mul_f32 v101, v101, v8
    v_mul_f32 v102, v102, v8
    v_mul_f32 v103, v103, v8
    v_mul_f32 v104, v104, v8
    v_mul_f32 v105, v105, v8
    v_mul_f32 v106, v106, v8
    v_mul_f32 v107, v107, v8
    v_cvt_pk_bf16_f32 v40, v96, v97
    v_cvt_pk_bf16_f32 v41, v98, v99
    v_cvt_pk_bf16_f32 v42, v100, v101
    v_cvt_pk_bf16_f32 v43, v102, v103
    v_cvt_pk_bf16_f32 v44, v104, v105
    v_cvt_pk_bf16_f32 v45, v106, v107
    v_permlane32_swap_b32 v40, v42
    v_permlane32_swap_b32 v41, v43
    s_mov_b32 exec_hi, 0
    buffer_store_dwordx2 v[44:45], v114, s[28:31], s22 offen sc1
    s_mov_b32 exec_hi, -1
    buffer_store_dwordx4 v[40:43], v15, s[28:31], s22 offen sc1
K2_NOFLAG:
    s_waitcnt lgkmcnt(0)
    s_barrier
    ds_read_b32 v10, v11
    s_waitcnt lgkmcnt(0)
    v_readfirstlane_b32 s3, v10
    s_nop 3
    s_cmp_gt_u32 s3, s20
    s_cbranch_scc1 K2_FALLBACK

K2_DONE:
K2_END:
    s_endpgm
K2_FALLBACK:
    s_mov_b32 s20, 1
    s_mov_b32 s3, 10485760
    v_mov_b32 v10, 0xff800000
    s_waitcnt vmcnt(0)

    s_mul_i32 s24, s19, 40960
    s_mul_i32 s25, s19, 2944
    s_mov_b32 m0, s25
    s_add_u32 s25, s25, 23552
    buffer_load_dwordx4 v22, s[28:31], s24 offen lds
    s_mov_b32 exec_hi, 0xffcfffff
    buffer_load_dwordx4 v23, s[28:31], s24 offen offset:1024 lds
    s_mov_b32 exec_hi, -1
    s_mov_b32 exec_lo, 0xfffff3ff
    s_mov_b32 exec_hi, 0x003ffffc
    buffer_load_dwordx4 v30, s[28:31], s24 offen offset:2048 lds
    s_mov_b64 exec, -1
    s_add_u32 s24, s24, 327680
    s_cmp_ge_u32 s24, 2621440
    s_cselect_b32 s24, 0x40000000, s24
    s_cmp_ge_u32 s25, 70656
    s_cselect_b32 s36, 70656, 0
    s_sub_u32 s25, s25, s36
    s_mov_b32 m0, s25
    s_add_u32 s25, s25, 23552
    buffer_load_dwordx4 v22, s[28:31], s24 offen lds
    s_mov_b32 exec_hi, 0xffcfffff
    buffer_load_dwordx4 v23, s[28:31], s24 offen offset:1024 lds
    s_mov_b32 exec_hi, -1
    s_mov_b32 exec_lo, 0xfffff3ff
    s_mov_b32 exec_hi, 0x003ffffc
    buffer_load_dwordx4 v30, s[28:31], s24 offen offset:2048 lds
    s_mov_b64 exec, -1
    s_add_u32 s24, s24, 327680
    s_cmp_ge_u32 s24, 2621440
    s_cselect_b32 s24, 0x40000000, s24
    s_cmp_ge_u32 s25, 70656
    s_cselect_b32 s36, 70656, 0
    s_sub_u32 s25, s25, s36
K2_MAXLOOP:
    buffer_load_dwordx4 v[24:27], v31, s[28:31], s3 offen
    buffer_load_dwordx2 v[28:29], v112, s[28:31], s3 offen
    s_waitcnt vmcnt(0)

    v_mfma_f32_32x32x16_bf16 v[64:79], v[24:27], v[16:19], 0
    v_mfma_f32_32x32x8_bf16 v[64:79], v[28:29], v[20:21], v[64:79]
    s_nop 15
    v_max3_f32 v10, v10, v64, v65
    v_max3_f32 v10, v10, v66, v67
    v_max3_f32 v10, v10, v68, v69
    v_max3_f32 v10, v10, v70, v71
    v_max3_f32 v10, v10, v72, v73
    v_max3_f32 v10, v10, v74, v75
    v_max3_f32 v10, v10, v76, v77
    v_max3_f32 v10, v10, v78, v79
    s_add_u32 s3, s3, 40960
    s_cmp_lt_u32 s3, 13107200
    s_cbranch_scc1 K2_MAXLOOP
    v_mov_b32 v11, v10
    s_nop 1
    v_permlane32_swap_b32 v10, v11
    s_nop 1
    v_max_f32 v10, v10, v11

    v_sub_f32 v48, 0, v10
    v_sub_f32 v49, 0, v10
    v_sub_f32 v50, 0, v10
    v_sub_f32 v51, 0, v10
    v_sub_f32 v52, 0, v10
    v_sub_f32 v53, 0, v10
    v_sub_f32 v54, 0, v10
    v_sub_f32 v55, 0, v10
    v_sub_f32 v56, 0, v10
    v_sub_f32 v57, 0, v10
    v_sub_f32 v58, 0, v10
    v_sub_f32 v59, 0, v10
    v_sub_f32 v60, 0, v10
    v_sub_f32 v61, 0, v10
    v_sub_f32 v62, 0, v10
    v_sub_f32 v63, 0, v10
    v_mov_b32 v96, 0
    v_mov_b32 v97, 0
    v_mov_b32 v98, 0
    v_mov_b32 v99, 0
    v_mov_b32 v100, 0
    v_mov_b32 v101, 0
    v_mov_b32 v102, 0
    v_mov_b32 v103, 0
    v_mov_b32 v104, 0
    v_mov_b32 v105, 0
    v_mov_b32 v106, 0
    v_mov_b32 v107, 0
    v_mov_b32 v108, 0
    v_mov_b32 v109, 0
    v_mov_b32 v110, 0
    v_mov_b32 v111, 0
    v_mov_b32 v44, 0
    v_mov_b32 v36, 0
    v_mov_b32 v45, 0
    v_mov_b32 v37, 0
    v_mov_b32 v46, 0
    v_mov_b32 v38, 0
    v_mov_b32 v47, 0
    v_mov_b32 v39, 0
    v_mov_b32 v7, v4
    v_mov_b32 v5, v2
    v_mov_b32 v6, v3
    s_mov_b32 s26, 23552
    s_mov_b32 s27, 0

    s_barrier
    ds_read_b128 v[24:27], v5 offset:0
    ds_read_b64 v[28:29], v6 offset:0
    s_branch K2_HAVE_M
K2_AROLE:
    s_load_dwordx2 s[48:49], s[0:1], 56
    s_setprio 1
    s_bfe_u32 s15, s2, 327683
    s_lshl_b32 s50, s14, 2
    s_and_b32 s3, s15, 3
    s_add_u32 s50, s50, s3
    s_lshr_b32 s51, s15, 2
    s_lshl_b32 s17, s51, 2
    s_lshr_b32 s3, s19, 1
    s_add_u32 s17, s17, s3
    s_lshl_b32 s18, s50, 1
    s_and_b32 s3, s19, 1
    s_add_u32 s18, s18, s3

    v_and_b32 v8, 31, v1
    v_lshrrev_b32 v9, 5, v1
    v_lshlrev_b32 v113, 4, v1
    s_and_b32 s4, s17, 1
    s_mul_i32 s5, s17, 5
    s_lshr_b32 s5, s5, 1
    s_lshl_b32 s5, s5, 9
    s_lshl_b32 s6, s4, 9
    s_cmp_eq_u32 s4, 0
    s_cselect_b32 s7, 1024, 8
    v_add_u32 v2, s6, v113
    v_lshl_add_u32 v3, v8, 4, s7
    v_add_u32 v31, s5, v2
    v_add_u32 v112, s5, v3
    s_mul_i32 s6, s17, 320
    s_mul_i32 s21, s18, 40960

    s_and_b32 s3, s18, 31
    s_cmp_lg_u32 s3, 0
    s_cselect_b32 s3, 40960, 0
    s_cselect_b64 s[46:47], -1, 0
    s_sub_u32 s24, s21, s3
    v_mov_b32 v10, 0xf149f2ca

    v_mov_b32 v32, 0x3f803f80
    v_mov_b32 v33, 0x3f803f80
    v_mov_b32 v34, 0x3f803f80
    v_mov_b32 v35, 0x3f803f80
    v_mov_b32 v36, 0x3f803f80
    v_mov_b32 v37, 0x3f803f80
    v_mov_b32 v38, 0x3f803f80
    v_mov_b32 v39, 0x3f803f80
    v_mov_b32 v40, 0x3f803f80
    v_mov_b32 v41, 0x3f803f80
    v_mov_b32 v42, 0x3f803f80
    v_mov_b32 v43, 0x3f803f80
    s_mov_b32 s38, 0x00000f0f
    s_mov_b32 s39, 0x0000f0f0
    v_cndmask_b32 v64, v10, 0, s[38:39]
    s_mov_b32 s40, 0x00000f1e
    s_mov_b32 s41, 0x0001f0e0
    v_cndmask_b32 v65, v10, 0, s[40:41]
    s_mov_b32 s42, 0x00000f3c
    s_mov_b32 s43, 0x0003f0c0
    v_cndmask_b32 v66, v10, 0, s[42:43]
    s_mov_b32 s38, 0x00000f78
    s_mov_b32 s39, 0x0007f080
    v_cndmask_b32 v67, v10, 0, s[38:39]
    s_mov_b32 s40, 0x00000ff0
    s_mov_b32 s41, 0x000ff000
    v_cndmask_b32 v68, v10, 0, s[40:41]
    s_mov_b32 s42, 0x00001ef0
    s_mov_b32 s43, 0x010fe000
    v_cndmask_b32 v69, v10, 0, s[42:43]
    s_mov_b32 s38, 0x00003cf0
    s_mov_b32 s39, 0x030fc000
    v_cndmask_b32 v70, v10, 0, s[38:39]
    s_mov_b32 s40, 0x000078f0
    s_mov_b32 s41, 0x070f8000
    v_cndmask_b32 v71, v10, 0, s[40:41]
    s_mov_b32 s42, 0x0f0f0000
    s_mov_b32 s43, 0xf0f00000
    v_cndmask_b32 v72, v10, 0, s[42:43]
    s_mov_b32 s38, 0x0f1e0000
    s_mov_b32 s39, 0xf0e00000
    v_cndmask_b32 v73, v10, 0, s[38:39]
    s_mov_b32 s40, 0x0f3c0000
    s_mov_b32 s41, 0xf0c00000
    v_cndmask_b32 v74, v10, 0, s[40:41]
    s_mov_b32 s42, 0x0f780000
    s_mov_b32 s43, 0xf0800000
    v_cndmask_b32 v75, v10, 0, s[42:43]
    s_mov_b32 s38, 0x0ff00000
    s_mov_b32 s39, 0xf0000000
    v_cndmask_b32 v76, v10, 0, s[38:39]
    s_mov_b32 s40, 0x1ef00000
    s_mov_b32 s41, 0xe0000000
    v_cndmask_b32 v77, v10, 0, s[40:41]
    s_mov_b32 s42, 0x3cf00000
    s_mov_b32 s43, 0xc0000000
    v_cndmask_b32 v78, v10, 0, s[42:43]
    s_mov_b32 s38, 0x78f00000
    s_mov_b32 s39, 0x80000000
    v_cndmask_b32 v79, v10, 0, s[38:39]
    s_and_b32 s40, s46, 0x00000000
    s_and_b32 s41, s46, 0x00000000
    v_cndmask_b32 v88, v10, 0, s[40:41]
    s_and_b32 s42, s46, 0x00000000
    s_and_b32 s43, s46, 0x00000001
    v_cndmask_b32 v89, v10, 0, s[42:43]
    s_and_b32 s38, s46, 0x00000000
    s_and_b32 s39, s46, 0x00000003
    v_cndmask_b32 v90, v10, 0, s[38:39]
    s_and_b32 s40, s46, 0x00000000
    s_and_b32 s41, s46, 0x00000007
    v_cndmask_b32 v91, v10, 0, s[40:41]
    s_and_b32 s42, s46, 0x00000000
    s_and_b32 s43, s46, 0x0000000f
    v_cndmask_b32 v92, v10, 0, s[42:43]
    s_and_b32 s38, s46, 0x00000000
    s_and_b32 s39, s46, 0x0000010f
    v_cndmask_b32 v93, v10, 0, s[38:39]
    s_and_b32 s40, s46, 0x00000000
    s_and_b32 s41, s46, 0x0000030f
    v_cndmask_b32 v94, v10, 0, s[40:41]
    s_and_b32 s42, s46, 0x00000000
    s_and_b32 s43, s46, 0x0000070f
    v_cndmask_b32 v95, v10, 0, s[42:43]
    s_waitcnt lgkmcnt(0)
    s_mov_b32 s28, s10
    s_mov_b32 s29, s11
    s_mov_b32 s30, 33554432
    s_mov_b32 s31, 0x00020000
    s_mov_b32 s56, s48
    s_mov_b32 s57, s49
    s_mov_b32 s58, 2621440
    s_mov_b32 s59, 0x00020000
    s_and_b32 s60, s2, 255
    s_lshl_b32 s60, s60, 7
    s_add_u32 s60, s60, 29425664
    s_lshl_b32 s5, s4, 2
    v_add_u32 v12, s5, v8
    v_subrev_u32 v13, 20, v12
    v_cmp_gt_u32 s[36:37], 20, v12
    v_cmp_gt_u32 s[38:39], 20, v8
    v_and_b32 v10, 3, v8
    v_cndmask_b32 v12, v13, v12, s[36:37]
    v_cndmask_b32 v12, v8, v12, s[38:39]
    v_bfe_u32 v11, v8, 2, 1
    v_lshl_or_b32 v10, v11, 3, v10
    v_bfe_u32 v11, v8, 3, 1
    v_lshl_or_b32 v10, v11, 2, v10
    v_lshrrev_b32 v11, 4, v8
    v_lshl_or_b32 v14, v11, 4, v10
    v_lshlrev_b32 v10, 4, v10
    v_mul_u32_u24 v11, 20480, v11
    s_mul_i32 s3, s17, 5
    s_add_u32 s3, s3, 1
    s_lshr_b32 s3, s3, 1
    s_lshl_b32 s3, s3, 8
    v_add3_u32 v10, v10, v11, s3
    v_lshl_add_u32 v15, v9, 8, v10
    s_mul_i32 s5, s4, 760
    s_sub_u32 s5, 512, s5
    v_add_u32 v114, s5, v10
    s_add_u32 s22, s21, 16777216
    v_lshlrev_b32 v122, 2, v14
    s_lshl_b32 s23, s18, 7
    s_add_u32 s23, s23, 29360128

    v_mul_u32_u24 v11, 10240, v9
    v_lshl_add_u32 v11, v12, 4, v11
    v_add_u32 v115, s6, v11

    v_mov_b32 v2, v113
    s_lshr_b32 s4, s19, 2
    s_mul_i32 s54, s4, 40960
    v_add_u32 v3, s54, v113
    s_mul_i32 s5, s4, 10240
    s_mul_i32 s52, s51, 102400
    s_add_u32 s52, s52, s5
    s_add_u32 s52, s52, 25165824
    s_lshl_b32 s6, s50, 2
    s_and_b32 s3, s19, 3
    s_add_u32 s6, s6, s3
    s_mul_i32 s53, s6, 20480
    s_add_u32 s53, s53, s5
    s_add_u32 s53, s53, 16777216
    s_mul_i32 s3, s3, 10240
    s_add_u32 s54, s54, s3
    v_and_b32 v9, 15, v1
    v_lshrrev_b32 v11, 4, v1
    v_mul_u32_u24 v12, 2560, v9
    v_and_b32 v13, 1, v11
    v_lshlrev_b32 v13, 5, v13
    v_lshrrev_b32 v14, 1, v11
    v_lshlrev_b32 v14, 4, v14
    v_add3_u32 v4, v12, v13, v14
    v_lshl_add_u32 v5, v11, 3, v12
    s_and_b32 s7, s6, 63
    s_mul_i32 s7, s7, 40960
    s_lshr_b32 s6, s6, 6
    s_mul_i32 s6, s6, 1280
    s_add_u32 s55, s6, s7
    s_mul_i32 s7, s51, 160
    s_add_u32 s55, s55, s7

    s_cmp_eq_u32 s19, 0
    s_cbranch_scc0 K2_SGO
    s_movk_i32 s9, 64
    v_mov_b32 v10, 0

K2_SPOLL:
    buffer_load_dword v11, v10, s[28:31], s60 offen offset:0 sc1
    s_waitcnt vmcnt(0)
    v_readfirstlane_b32 s3, v11
    s_sub_u32 s9, s9, 1
    s_nop 2
    s_cmp_ge_u32 s3, 1
    s_cbranch_scc1 K2_SPOLL_OK
    s_sleep 12
    s_cmp_lg_u32 s9, 0
    s_cbranch_scc1 K2_SPOLL

K2_SPOLL_OK:
K2_SGO:
    s_barrier
    buffer_load_dword v122, v122, s[28:31], s23 offen
    s_add_u32 s3, s21, 2621440
    s_add_u32 s4, s24, 2621440

    buffer_load_dwordx4 v[16:19], v31, s[28:31], s21 offen
    buffer_load_dwordx2 v[20:21], v112, s[28:31], s21 offen
    buffer_load_dwordx4 v[24:27], v31, s[28:31], s3 offen
    buffer_load_dwordx2 v[28:29], v112, s[28:31], s3 offen
    buffer_load_dwordx4 v[116:119], v31, s[28:31], s4 offen
    buffer_load_dwordx2 v[120:121], v112, s[28:31], s4 offen
    s_add_u32 s3, s21, 5242880
    s_add_u32 s4, s3, 20480
    s_add_u32 s5, s24, 5263360
    s_mov_b32 exec_lo, 0x000fffff
    s_mov_b32 exec_hi, 0x000fffff
    buffer_load_dwordx4 v[32:35], v115, s[28:31], s3 offen
    buffer_load_dwordx4 v[36:39], v115, s[28:31], s4 offen
    buffer_load_dwordx4 v[40:43], v115, s[28:31], s5 offen
    s_mov_b64 exec, -1
    s_waitcnt vmcnt(3)
    s_mov_b32 exec_lo, 0
    v_mov_b32 v20, 0
    v_mov_b32 v21, 0
    s_mov_b32 exec_lo, -1
    s_nop 1

    v_mfma_f32_32x32x16_bf16 v[64:79], v[24:27], v[16:19], v[64:79]
    v_mfma_f32_32x32x8_bf16 v[64:79], v[28:29], v[20:21], v[64:79]
    v_mfma_f32_32x32x16_bf16 v[80:95], v[116:119], v[16:19], v[80:95]
    v_mfma_f32_32x32x8_bf16 v[80:95], v[120:121], v[20:21], v[80:95]
    s_nop 11
    v_max3_f32 v8, v64, v65, v66
    v_max3_f32 v8, v8, v67, v68
    v_max3_f32 v8, v8, v69, v70
    v_max3_f32 v8, v8, v71, v72
    v_max3_f32 v8, v8, v73, v74
    v_max3_f32 v8, v8, v75, v76
    v_max3_f32 v8, v8, v77, v78
    v_max3_f32 v8, v8, v79, v88
    v_max3_f32 v8, v8, v89, v90
    v_max3_f32 v8, v8, v91, v92
    v_max3_f32 v8, v8, v93, v94
    v_max_f32 v8, v8, v95
    v_mov_b32 v9, v8
    s_nop 1
    v_permlane32_swap_b32 v8, v9
    s_nop 1
    v_max_f32 v8, v8, v9
    v_sub_f32 v64, v64, v8
    v_sub_f32 v65, v65, v8
    v_sub_f32 v66, v66, v8
    v_sub_f32 v67, v67, v8
    v_sub_f32 v68, v68, v8
    v_sub_f32 v69, v69, v8
    v_sub_f32 v70, v70, v8
    v_sub_f32 v71, v71, v8
    v_sub_f32 v72, v72, v8
    v_sub_f32 v73, v73, v8
    v_sub_f32 v74, v74, v8
    v_sub_f32 v75, v75, v8
    v_sub_f32 v76, v76, v8
    v_sub_f32 v77, v77, v8
    v_sub_f32 v78, v78, v8
    v_sub_f32 v79, v79, v8
    v_sub_f32 v88, v88, v8
    v_sub_f32 v89, v89, v8
    v_sub_f32 v90, v90, v8
    v_sub_f32 v91, v91, v8
    v_sub_f32 v92, v92, v8
    v_sub_f32 v93, v93, v8
    v_sub_f32 v94, v94, v8
    v_sub_f32 v95, v95, v8
    v_exp_f32 v64, v64
    v_exp_f32 v65, v65
    v_exp_f32 v66, v66
    v_exp_f32 v67, v67
    v_exp_f32 v68, v68
    v_exp_f32 v69, v69
    v_exp_f32 v70, v70
    v_exp_f32 v71, v71
    v_exp_f32 v72, v72
    v_exp_f32 v73, v73
    v_exp_f32 v74, v74
    v_exp_f32 v75, v75
    v_exp_f32 v76, v76
    v_exp_f32 v77, v77
    v_exp_f32 v78, v78
    v_exp_f32 v79, v79
    v_exp_f32 v88, v88
    v_exp_f32 v89, v89
    v_exp_f32 v90, v90
    v_exp_f32 v91, v91
    v_exp_f32 v92, v92
    v_exp_f32 v93, v93
    v_exp_f32 v94, v94
    v_exp_f32 v95, v95
    s_waitcnt vmcnt(0)
    v_cvt_pk_bf16_f32 v48, v64, v65
    v_cvt_pk_bf16_f32 v49, v66, v67
    v_cvt_pk_bf16_f32 v50, v68, v69
    v_cvt_pk_bf16_f32 v51, v70, v71
    v_cvt_pk_bf16_f32 v52, v72, v73
    v_cvt_pk_bf16_f32 v53, v74, v75
    v_cvt_pk_bf16_f32 v54, v76, v77
    v_cvt_pk_bf16_f32 v55, v78, v79
    v_cvt_pk_bf16_f32 v56, v88, v89
    v_cvt_pk_bf16_f32 v57, v90, v91
    v_cvt_pk_bf16_f32 v58, v92, v93
    v_cvt_pk_bf16_f32 v59, v94, v95
    s_nop 1
    v_mfma_f32_32x32x16_bf16 v[96:111], v[32:35], v[48:51], 0
    v_mfma_f32_32x32x16_bf16 v[96:111], v[36:39], v[52:55], v[96:111]
    v_mfma_f32_32x32x16_bf16 v[96:111], v[40:43], v[56:59], v[96:111]
    s_nop 11

    v_mov_b32 v8, v104
    v_mov_b32 v9, v104
    s_nop 1
    v_permlane32_swap_b32 v8, v9
    s_nop 1
    v_rcp_f32 v8, v9
    s_nop 0
    v_mul_f32 v8, v8, v122

    v_mul_f32 v96, v96, v8
    v_mul_f32 v97, v97, v8
    v_mul_f32 v98, v98, v8
    v_mul_f32 v99, v99, v8
    v_mul_f32 v100, v100, v8
    v_mul_f32 v101, v101, v8
    v_mul_f32 v102, v102, v8
    v_mul_f32 v103, v103, v8
    v_mul_f32 v104, v104, v8
    v_mul_f32 v105, v105, v8
    v_mul_f32 v106, v106, v8
    v_mul_f32 v107, v107, v8
    v_cvt_pk_bf16_f32 v116, v96, v97
    v_cvt_pk_bf16_f32 v117, v98, v99
    v_cvt_pk_bf16_f32 v118, v100, v101
    v_cvt_pk_bf16_f32 v119, v102, v103
    v_cvt_pk_bf16_f32 v120, v104, v105
    v_cvt_pk_bf16_f32 v121, v106, v107
    v_permlane32_swap_b32 v116, v118
    v_permlane32_swap_b32 v117, v119
    s_mov_b32 exec_hi, 0
    buffer_store_dwordx2 v[120:121], v114, s[28:31], s22 offen sc1
    s_mov_b32 exec_hi, -1
    buffer_store_dwordx4 v[116:119], v15, s[28:31], s22 offen sc1
    v_lshlrev_b32 v6, 12, v1
    v_mov_b32 v9, 1
    s_and_b32 s7, s2, 31
    s_lshl_b32 s7, s7, 7
    s_add_u32 s7, s7, 29425672
    s_waitcnt vmcnt(0)
    s_barrier
    s_cmp_eq_u32 s19, 0
    s_cbranch_scc0 K2_PNOSIG
    s_mov_b64 exec, 0xff
    buffer_atomic_add v9, v6, s[28:31], s7 offen sc1
    s_mov_b64 exec, -1

K2_PNOSIG:
    v_mov_b32 v16, 0
    v_mov_b32 v17, 0
    v_mov_b32 v18, 0
    v_mov_b32 v19, 0
    v_mov_b32 v20, 0
    v_mov_b32 v21, 0
    v_mov_b32 v22, 0
    v_mov_b32 v23, 0
    v_mov_b32 v24, 0
    v_mov_b32 v25, 0
    v_mov_b32 v26, 0
    v_mov_b32 v27, 0
    v_mov_b32 v28, 0
    v_mov_b32 v29, 0
    v_mov_b32 v30, 0
    v_mov_b32 v31, 0
    v_mov_b32 v32, 0
    v_mov_b32 v33, 0
    v_mov_b32 v34, 0
    v_mov_b32 v35, 0
    s_mov_b32 s27, 0
K2_PROUND:
    s_and_b32 s3, s19, 3
    s_lshl_b32 s3, s3, 11
    s_add_u32 s4, s52, s3

    s_add_u32 m0, s54, 0
    s_nop 0
    buffer_load_dwordx4 v2, s[28:31], s4 offen lds
    s_add_u32 m0, s54, 4096
    s_nop 0
    buffer_load_dwordx4 v2, s[28:31], s4 offen offset:1024 lds
    s_add_u32 m0, s54, 1024
    s_add_u32 s4, s4, 20480
    buffer_load_dwordx4 v2, s[28:31], s4 offen lds
    s_add_u32 m0, s54, 5120
    s_nop 0
    buffer_load_dwordx4 v2, s[28:31], s4 offen offset:1024 lds
    s_add_u32 m0, s54, 2048
    s_add_u32 s4, s4, 20480
    buffer_load_dwordx4 v2, s[28:31], s4 offen lds
    s_add_u32 m0, s54, 6144
    s_nop 0
    buffer_load_dwordx4 v2, s[28:31], s4 offen offset:1024 lds
    s_add_u32 m0, s54, 3072
    s_add_u32 s4, s4, 20480
    buffer_load_dwordx4 v2, s[28:31], s4 offen lds
    s_add_u32 m0, s54, 7168
    s_nop 0
    buffer_load_dwordx4 v2, s[28:31], s4 offen offset:1024 lds
    s_add_u32 m0, s54, 4096
    s_add_u32 s4, s4, 20480
    buffer_load_dwordx4 v2, s[28:31], s4 offen lds
    s_add_u32 m0, s54, 8192
    s_nop 0
    buffer_load_dwordx4 v2, s[28:31], s4 offen offset:1024 lds
    s_add_u32 s4, s52, 8192
    buffer_load_dwordx4 v[76:79], v2, s[28:31], s4 offen
    buffer_load_dwordx4 v[96:99], v2, s[28:31], s4 offen offset:1024
    s_add_u32 s4, s4, 20480
    buffer_load_dwordx4 v[80:83], v2, s[28:31], s4 offen
    buffer_load_dwordx4 v[100:103], v2, s[28:31], s4 offen offset:1024
    s_add_u32 s4, s4, 20480
    buffer_load_dwordx4 v[84:87], v2, s[28:31], s4 offen
    buffer_load_dwordx4 v[104:107], v2, s[28:31], s4 offen offset:1024
    s_add_u32 s4, s4, 20480
    buffer_load_dwordx4 v[88:91], v2, s[28:31], s4 offen
    buffer_load_dwordx4 v[108:111], v2, s[28:31], s4 offen offset:1024
    s_add_u32 s4, s4, 20480
    buffer_load_dwordx4 v[92:95], v2, s[28:31], s4 offen
    buffer_load_dwordx4 v[112:115], v2, s[28:31], s4 offen offset:1024
    s_cmp_eq_u32 s19, 0
    s_cbranch_scc0 K2_PGO
    s_cmp_lg_u32 s27, 0
    s_cbranch_scc1 K2_PWB

    s_movk_i32 s9, 8192
    v_mov_b32 v10, 0

K2_POLLA:
    buffer_load_dword v11, v10, s[28:31], s60 offen offset:8 sc1
    s_waitcnt vmcnt(0)
    v_readfirstlane_b32 s3, v11
    s_sub_u32 s9, s9, 1
    s_nop 2
    s_cmp_ge_u32 s3, 8
    s_cbranch_scc1 K2_POLLA_OK
    s_sleep 12
    s_cmp_lg_u32 s9, 0
    s_cbranch_scc1 K2_POLLA

K2_POLLA_OK:
    s_branch K2_PGO
K2_PWB:
    s_movk_i32 s9, 2048
    v_mov_b32 v10, 0

K2_POLLE:
    buffer_load_dword v11, v10, s[28:31], s60 offen offset:0 sc1
    s_waitcnt vmcnt(0)
    v_readfirstlane_b32 s3, v11
    s_sub_u32 s9, s9, 1
    s_nop 2
    s_cmp_ge_u32 s3, 2
    s_cbranch_scc1 K2_POLLE_OK
    s_sleep 48
    s_cmp_lg_u32 s9, 0
    s_cbranch_scc1 K2_POLLE

K2_POLLE_OK:
    s_movk_i32 s9, 16384
    v_mov_b32 v10, 0

K2_POLLB:
    buffer_load_dword v11, v10, s[28:31], s60 offen offset:4 sc1
    s_waitcnt vmcnt(0)
    v_readfirstlane_b32 s3, v11
    s_sub_u32 s9, s9, 1
    s_nop 2
    s_cmp_ge_u32 s3, 32
    s_cbranch_scc1 K2_POLLB_OK
    s_sleep 4
    s_cmp_lg_u32 s9, 0
    s_cbranch_scc1 K2_POLLB

K2_POLLB_OK:
K2_PGO:
    s_waitcnt vmcnt(0)
    s_barrier
    s_add_u32 s4, s53, 8192
    buffer_load_dwordx4 v[68:71], v2, s[28:31], s4 offen offset:0 sc1
    buffer_load_dwordx4 v[72:75], v2, s[28:31], s4 offen offset:1024 sc1
    s_add_u32 s6, s53, 0
    buffer_load_dwordx4 v[36:39], v2, s[28:31], s6 offen sc1
    s_add_u32 s6, s53, 1024
    buffer_load_dwordx4 v[40:43], v2, s[28:31], s6 offen sc1
    s_add_u32 s6, s53, 2048
    buffer_load_dwordx4 v[44:47], v2, s[28:31], s6 offen sc1
    s_add_u32 s6, s53, 3072
    buffer_load_dwordx4 v[48:51], v2, s[28:31], s6 offen sc1
    s_add_u32 s6, s53, 4096
    buffer_load_dwordx4 v[52:55], v2, s[28:31], s6 offen sc1
    s_add_u32 s6, s53, 5120
    buffer_load_dwordx4 v[56:59], v2, s[28:31], s6 offen sc1
    s_add_u32 s6, s53, 6144
    buffer_load_dwordx4 v[60:63], v2, s[28:31], s6 offen sc1
    s_add_u32 s6, s53, 7168
    buffer_load_dwordx4 v[64:67], v2, s[28:31], s6 offen sc1
    s_mov_b32 s9, 0x10000
    s_waitcnt vmcnt(9)
K2_PCHK0:
    v_max3_u32 v8, v68, v69, v70
    v_max_u32 v8, v8, v71
    v_cmp_eq_u32 vcc, -1, v8
    s_mov_b32 s3, 0
    v_add_u32 v7, s3, v3
    s_cbranch_vccnz K2_PRETRY0
K2_PCONT0:
    v_mfma_f32_16x16x32_bf16 v[16:19], v[76:79], v[68:71], v[16:19]
    v_mfma_f32_16x16x32_bf16 v[20:23], v[80:83], v[68:71], v[20:23]
    v_mfma_f32_16x16x32_bf16 v[24:27], v[84:87], v[68:71], v[24:27]
    v_mfma_f32_16x16x32_bf16 v[28:31], v[88:91], v[68:71], v[28:31]
    v_mfma_f32_16x16x32_bf16 v[32:35], v[92:95], v[68:71], v[32:35]
    ds_read_b128 v[76:79], v7 offset:0
    ds_read_b128 v[80:83], v7 offset:1024
    ds_read_b128 v[84:87], v7 offset:2048
    ds_read_b128 v[88:91], v7 offset:3072
    ds_read_b128 v[92:95], v7 offset:4096
    s_waitcnt vmcnt(8)
K2_PCHK1:
    v_max3_u32 v8, v72, v73, v74
    v_max_u32 v8, v8, v75
    v_cmp_eq_u32 vcc, -1, v8
    s_mov_b32 s3, 5120
    v_add_u32 v7, s3, v3
    s_cbranch_vccnz K2_PRETRY1
K2_PCONT1:
    v_mfma_f32_16x16x32_bf16 v[16:19], v[96:99], v[72:75], v[16:19]
    v_mfma_f32_16x16x32_bf16 v[20:23], v[100:103], v[72:75], v[20:23]
    v_mfma_f32_16x16x32_bf16 v[24:27], v[104:107], v[72:75], v[24:27]
    v_mfma_f32_16x16x32_bf16 v[28:31], v[108:111], v[72:75], v[28:31]
    v_mfma_f32_16x16x32_bf16 v[32:35], v[112:115], v[72:75], v[32:35]
    ds_read_b128 v[96:99], v7 offset:0
    ds_read_b128 v[100:103], v7 offset:1024
    ds_read_b128 v[104:107], v7 offset:2048
    ds_read_b128 v[108:111], v7 offset:3072
    ds_read_b128 v[112:115], v7 offset:4096
    s_waitcnt vmcnt(7) lgkmcnt(5)
K2_PCHK2:
    v_max3_u32 v8, v36, v37, v38
    v_max_u32 v8, v8, v39
    v_cmp_eq_u32 vcc, -1, v8
    s_mov_b32 s3, 10240
    v_add_u32 v7, s3, v3
    s_cbranch_vccnz K2_PRETRY2
K2_PCONT2:
    v_mfma_f32_16x16x32_bf16 v[16:19], v[76:79], v[36:39], v[16:19]
    v_mfma_f32_16x16x32_bf16 v[20:23], v[80:83], v[36:39], v[20:23]
    v_mfma_f32_16x16x32_bf16 v[24:27], v[84:87], v[36:39], v[24:27]
    v_mfma_f32_16x16x32_bf16 v[28:31], v[88:91], v[36:39], v[28:31]
    v_mfma_f32_16x16x32_bf16 v[32:35], v[92:95], v[36:39], v[32:35]
    ds_read_b128 v[76:79], v7 offset:0
    ds_read_b128 v[80:83], v7 offset:1024
    ds_read_b128 v[84:87], v7 offset:2048
    ds_read_b128 v[88:91], v7 offset:3072
    ds_read_b128 v[92:95], v7 offset:4096
    s_waitcnt vmcnt(6) lgkmcnt(5)
K2_PCHK3:
    v_max3_u32 v8, v40, v41, v42
    v_max_u32 v8, v8, v43
    v_cmp_eq_u32 vcc, -1, v8
    s_mov_b32 s3, 15360
    v_add_u32 v7, s3, v3
    s_cbranch_vccnz K2_PRETRY3
K2_PCONT3:
    v_mfma_f32_16x16x32_bf16 v[16:19], v[96:99], v[40:43], v[16:19]
    v_mfma_f32_16x16x32_bf16 v[20:23], v[100:103], v[40:43], v[20:23]
    v_mfma_f32_16x16x32_bf16 v[24:27], v[104:107], v[40:43], v[24:27]
    v_mfma_f32_16x16x32_bf16 v[28:31], v[108:111], v[40:43], v[28:31]
    v_mfma_f32_16x16x32_bf16 v[32:35], v[112:115], v[40:43], v[32:35]
    ds_read_b128 v[96:99], v7 offset:0
    ds_read_b128 v[100:103], v7 offset:1024
    ds_read_b128 v[104:107], v7 offset:2048
    ds_read_b128 v[108:111], v7 offset:3072
    ds_read_b128 v[112:115], v7 offset:4096
    s_waitcnt vmcnt(5) lgkmcnt(5)
K2_PCHK4:
    v_max3_u32 v8, v44, v45, v46
    v_max_u32 v8, v8, v47
    v_cmp_eq_u32 vcc, -1, v8
    s_mov_b32 s3, 20480
    v_add_u32 v7, s3, v3
    s_cbranch_vccnz K2_PRETRY4
K2_PCONT4:
    v_mfma_f32_16x16x32_bf16 v[16:19], v[76:79], v[44:47], v[16:19]
    v_mfma_f32_16x16x32_bf16 v[20:23], v[80:83], v[44:47], v[20:23]
    v_mfma_f32_16x16x32_bf16 v[24:27], v[84:87], v[44:47], v[24:27]
    v_mfma_f32_16x16x32_bf16 v[28:31], v[88:91], v[44:47], v[28:31]
    v_mfma_f32_16x16x32_bf16 v[32:35], v[92:95], v[44:47], v[32:35]
    ds_read_b128 v[76:79], v7 offset:0
    ds_read_b128 v[80:83], v7 offset:1024
    ds_read_b128 v[84:87], v7 offset:2048
    ds_read_b128 v[88:91], v7 offset:3072
    ds_read_b128 v[92:95], v7 offset:4096
    s_waitcnt vmcnt(4) lgkmcnt(5)
K2_PCHK5:
    v_max3_u32 v8, v48, v49, v50
    v_max_u32 v8, v8, v51
    v_cmp_eq_u32 vcc, -1, v8
    s_mov_b32 s3, 25600
    v_add_u32 v7, s3, v3
    s_cbranch_vccnz K2_PRETRY5
K2_PCONT5:
    v_mfma_f32_16x16x32_bf16 v[16:19], v[96:99], v[48:51], v[16:19]
    v_mfma_f32_16x16x32_bf16 v[20:23], v[100:103], v[48:51], v[20:23]
    v_mfma_f32_16x16x32_bf16 v[24:27], v[104:107], v[48:51], v[24:27]
    v_mfma_f32_16x16x32_bf16 v[28:31], v[108:111], v[48:51], v[28:31]
    v_mfma_f32_16x16x32_bf16 v[32:35], v[112:115], v[48:51], v[32:35]
    ds_read_b128 v[96:99], v7 offset:0
    ds_read_b128 v[100:103], v7 offset:1024
    ds_read_b128 v[104:107], v7 offset:2048
    ds_read_b128 v[108:111], v7 offset:3072
    ds_read_b128 v[112:115], v7 offset:4096
    s_waitcnt vmcnt(3) lgkmcnt(5)
K2_PCHK6:
    v_max3_u32 v8, v52, v53, v54
    v_max_u32 v8, v8, v55
    v_cmp_eq_u32 vcc, -1, v8
    s_mov_b32 s3, 30720
    v_add_u32 v7, s3, v3
    s_cbranch_vccnz K2_PRETRY6
K2_PCONT6:
    v_mfma_f32_16x16x32_bf16 v[16:19], v[76:79], v[52:55], v[16:19]
    v_mfma_f32_16x16x32_bf16 v[20:23], v[80:83], v[52:55], v[20:23]
    v_mfma_f32_16x16x32_bf16 v[24:27], v[84:87], v[52:55], v[24:27]
    v_mfma_f32_16x16x32_bf16 v[28:31], v[88:91], v[52:55], v[28:31]
    v_mfma_f32_16x16x32_bf16 v[32:35], v[92:95], v[52:55], v[32:35]
    ds_read_b128 v[76:79], v7 offset:0
    ds_read_b128 v[80:83], v7 offset:1024
    ds_read_b128 v[84:87], v7 offset:2048
    ds_read_b128 v[88:91], v7 offset:3072
    ds_read_b128 v[92:95], v7 offset:4096
    s_waitcnt vmcnt(2) lgkmcnt(5)
K2_PCHK7:
    v_max3_u32 v8, v56, v57, v58
    v_max_u32 v8, v8, v59
    v_cmp_eq_u32 vcc, -1, v8
    s_mov_b32 s3, 35840
    v_add_u32 v7, s3, v3
    s_cbranch_vccnz K2_PRETRY7
K2_PCONT7:
    v_mfma_f32_16x16x32_bf16 v[16:19], v[96:99], v[56:59], v[16:19]
    v_mfma_f32_16x16x32_bf16 v[20:23], v[100:103], v[56:59], v[20:23]
    v_mfma_f32_16x16x32_bf16 v[24:27], v[104:107], v[56:59], v[24:27]
    v_mfma_f32_16x16x32_bf16 v[28:31], v[108:111], v[56:59], v[28:31]
    v_mfma_f32_16x16x32_bf16 v[32:35], v[112:115], v[56:59], v[32:35]
    ds_read_b128 v[96:99], v7 offset:0
    ds_read_b128 v[100:103], v7 offset:1024
    ds_read_b128 v[104:107], v7 offset:2048
    ds_read_b128 v[108:111], v7 offset:3072
    ds_read_b128 v[112:115], v7 offset:4096
    s_waitcnt vmcnt(1) lgkmcnt(5)
K2_PCHK8:
    v_max3_u32 v8, v60, v61, v62
    v_max_u32 v8, v8, v63
    v_cmp_eq_u32 vcc, -1, v8
    s_cbranch_vccnz K2_PRETRY8
K2_PCONT8:
    v_mfma_f32_16x16x32_bf16 v[16:19], v[76:79], v[60:63], v[16:19]
    v_mfma_f32_16x16x32_bf16 v[20:23], v[80:83], v[60:63], v[20:23]
    v_mfma_f32_16x16x32_bf16 v[24:27], v[84:87], v[60:63], v[24:27]
    v_mfma_f32_16x16x32_bf16 v[28:31], v[88:91], v[60:63], v[28:31]
    v_mfma_f32_16x16x32_bf16 v[32:35], v[92:95], v[60:63], v[32:35]
    s_waitcnt vmcnt(0) lgkmcnt(0)
K2_PCHK9:
    v_max3_u32 v8, v64, v65, v66
    v_max_u32 v8, v8, v67
    v_cmp_eq_u32 vcc, -1, v8
    s_cbranch_vccnz K2_PRETRY9
K2_PCONT9:
    v_mfma_f32_16x16x32_bf16 v[16:19], v[96:99], v[64:67], v[16:19]
    v_mfma_f32_16x16x32_bf16 v[20:23], v[100:103], v[64:67], v[20:23]
    v_mfma_f32_16x16x32_bf16 v[24:27], v[104:107], v[64:67], v[24:27]
    v_mfma_f32_16x16x32_bf16 v[28:31], v[108:111], v[64:67], v[28:31]
    v_mfma_f32_16x16x32_bf16 v[32:35], v[112:115], v[64:67], v[32:35]
    s_barrier
    s_cmp_lg_u32 s27, 0
    s_cbranch_scc1 K2_PFIN
    s_mov_b32 s27, 1
    s_add_u32 s52, s52, 819200
    s_add_u32 s53, s53, 2621440

    s_branch K2_PROUND
K2_PFIN:
    s_and_b32 s3, s19, 3
    s_mul_i32 s3, s3, 5120
    v_add_u32 v3, s3, v2
    s_cmp_lt_u32 s19, 4
    s_cbranch_scc1 K2_PSUM

    ds_write_b128 v3, v[16:19] offset:0
    ds_write_b128 v3, v[20:23] offset:1024
    ds_write_b128 v3, v[24:27] offset:2048
    ds_write_b128 v3, v[28:31] offset:3072
    ds_write_b128 v3, v[32:35] offset:4096
    s_waitcnt lgkmcnt(0)
    s_barrier
    s_branch K2_DONE
K2_PSUM:
    s_barrier
    ds_read_b128 v[36:39], v3 offset:0
    ds_read_b128 v[40:43], v3 offset:1024
    ds_read_b128 v[44:47], v3 offset:2048
    ds_read_b128 v[48:51], v3 offset:3072
    ds_read_b128 v[52:55], v3 offset:4096
    s_waitcnt lgkmcnt(0)
    v_add_f32 v16, v16, v36
    v_add_f32 v17, v17, v37
    v_add_f32 v18, v18, v38
    v_add_f32 v19, v19, v39
    v_add_f32 v20, v20, v40
    v_add_f32 v21, v21, v41
    v_add_f32 v22, v22, v42
    v_add_f32 v23, v23, v43
    v_add_f32 v24, v24, v44
    v_add_f32 v25, v25, v45
    v_add_f32 v26, v26, v46
    v_add_f32 v27, v27, v47
    v_add_f32 v28, v28, v48
    v_add_f32 v29, v29, v49
    v_add_f32 v30, v30, v50
    v_add_f32 v31, v31, v51
    v_add_f32 v32, v32, v52
    v_add_f32 v33, v33, v53
    v_add_f32 v34, v34, v54
    v_add_f32 v35, v35, v55
    v_cvt_pk_bf16_f32 v16, v16, v17
    v_cvt_pk_bf16_f32 v17, v18, v19
    v_cvt_pk_bf16_f32 v18, v20, v21
    v_cvt_pk_bf16_f32 v19, v22, v23
    s_nop 1
    v_permlane16_swap_b32 v16, v18
    v_permlane16_swap_b32 v17, v19
    s_nop 0
    buffer_store_dwordx4 v[16:19], v4, s[56:59], s55 offen offset:0
    v_cvt_pk_bf16_f32 v24, v24, v25
    v_cvt_pk_bf16_f32 v25, v26, v27
    v_cvt_pk_bf16_f32 v26, v28, v29
    v_cvt_pk_bf16_f32 v27, v30, v31
    s_nop 1
    v_permlane16_swap_b32 v24, v26
    v_permlane16_swap_b32 v25, v27
    s_nop 0
    buffer_store_dwordx4 v[24:27], v4, s[56:59], s55 offen offset:64
    v_cvt_pk_bf16_f32 v32, v32, v33
    v_cvt_pk_bf16_f32 v33, v34, v35
    buffer_store_dwordx2 v[32:33], v5, s[56:59], s55 offen offset:128
    s_branch K2_DONE
K2_PRETRY0:
    s_sub_u32 s9, s9, 1
    s_cmp_eq_u32 s9, 0
    s_cbranch_scc1 K2_PGIVE0
    s_waitcnt vmcnt(0)

    s_add_u32 s5, s53, 8192
    buffer_load_dwordx4 v[68:71], v2, s[28:31], s5 offen sc1
    s_add_u32 s5, s53, 9216
    buffer_load_dwordx4 v[72:75], v2, s[28:31], s5 offen sc1
    s_add_u32 s5, s53, 0
    buffer_load_dwordx4 v[36:39], v2, s[28:31], s5 offen sc1
    s_add_u32 s5, s53, 1024
    buffer_load_dwordx4 v[40:43], v2, s[28:31], s5 offen sc1
    s_add_u32 s5, s53, 2048
    buffer_load_dwordx4 v[44:47], v2, s[28:31], s5 offen sc1
    s_add_u32 s5, s53, 3072
    buffer_load_dwordx4 v[48:51], v2, s[28:31], s5 offen sc1
    s_add_u32 s5, s53, 4096
    buffer_load_dwordx4 v[52:55], v2, s[28:31], s5 offen sc1
    s_add_u32 s5, s53, 5120
    buffer_load_dwordx4 v[56:59], v2, s[28:31], s5 offen sc1
    s_add_u32 s5, s53, 6144
    buffer_load_dwordx4 v[60:63], v2, s[28:31], s5 offen sc1
    s_add_u32 s5, s53, 7168
    buffer_load_dwordx4 v[64:67], v2, s[28:31], s5 offen sc1
    s_waitcnt vmcnt(9)
    s_branch K2_PCHK0
K2_PGIVE0:
    s_mov_b32 s9, 1
    s_branch K2_PCONT0
K2_PRETRY1:
    s_sub_u32 s9, s9, 1
    s_cmp_eq_u32 s9, 0
    s_cbranch_scc1 K2_PGIVE1
    s_waitcnt vmcnt(0)

    s_add_u32 s5, s53, 9216
    buffer_load_dwordx4 v[72:75], v2, s[28:31], s5 offen sc1
    s_add_u32 s5, s53, 0
    buffer_load_dwordx4 v[36:39], v2, s[28:31], s5 offen sc1
    s_add_u32 s5, s53, 1024
    buffer_load_dwordx4 v[40:43], v2, s[28:31], s5 offen sc1
    s_add_u32 s5, s53, 2048
    buffer_load_dwordx4 v[44:47], v2, s[28:31], s5 offen sc1
    s_add_u32 s5, s53, 3072
    buffer_load_dwordx4 v[48:51], v2, s[28:31], s5 offen sc1
    s_add_u32 s5, s53, 4096
    buffer_load_dwordx4 v[52:55], v2, s[28:31], s5 offen sc1
    s_add_u32 s5, s53, 5120
    buffer_load_dwordx4 v[56:59], v2, s[28:31], s5 offen sc1
    s_add_u32 s5, s53, 6144
    buffer_load_dwordx4 v[60:63], v2, s[28:31], s5 offen sc1
    s_add_u32 s5, s53, 7168
    buffer_load_dwordx4 v[64:67], v2, s[28:31], s5 offen sc1
    s_waitcnt vmcnt(8)
    s_branch K2_PCHK1
K2_PGIVE1:
    s_mov_b32 s9, 1
    s_branch K2_PCONT1
K2_PRETRY2:
    s_sub_u32 s9, s9, 1
    s_cmp_eq_u32 s9, 0
    s_cbranch_scc1 K2_PGIVE2
    s_waitcnt vmcnt(0)

    s_add_u32 s5, s53, 0
    buffer_load_dwordx4 v[36:39], v2, s[28:31], s5 offen sc1
    s_add_u32 s5, s53, 1024
    buffer_load_dwordx4 v[40:43], v2, s[28:31], s5 offen sc1
    s_add_u32 s5, s53, 2048
    buffer_load_dwordx4 v[44:47], v2, s[28:31], s5 offen sc1
    s_add_u32 s5, s53, 3072
    buffer_load_dwordx4 v[48:51], v2, s[28:31], s5 offen sc1
    s_add_u32 s5, s53, 4096
    buffer_load_dwordx4 v[52:55], v2, s[28:31], s5 offen sc1
    s_add_u32 s5, s53, 5120
    buffer_load_dwordx4 v[56:59], v2, s[28:31], s5 offen sc1
    s_add_u32 s5, s53, 6144
    buffer_load_dwordx4 v[60:63], v2, s[28:31], s5 offen sc1
    s_add_u32 s5, s53, 7168
    buffer_load_dwordx4 v[64:67], v2, s[28:31], s5 offen sc1
    s_waitcnt vmcnt(7)
    s_branch K2_PCHK2
K2_PGIVE2:
    s_mov_b32 s9, 1
    s_branch K2_PCONT2
K2_PRETRY3:
    s_sub_u32 s9, s9, 1
    s_cmp_eq_u32 s9, 0
    s_cbranch_scc1 K2_PGIVE3
    s_waitcnt vmcnt(0)

    s_add_u32 s5, s53, 1024
    buffer_load_dwordx4 v[40:43], v2, s[28:31], s5 offen sc1
    s_add_u32 s5, s53, 2048
    buffer_load_dwordx4 v[44:47], v2, s[28:31], s5 offen sc1
    s_add_u32 s5, s53, 3072
    buffer_load_dwordx4 v[48:51], v2, s[28:31], s5 offen sc1
    s_add_u32 s5, s53, 4096
    buffer_load_dwordx4 v[52:55], v2, s[28:31], s5 offen sc1
    s_add_u32 s5, s53, 5120
    buffer_load_dwordx4 v[56:59], v2, s[28:31], s5 offen sc1
    s_add_u32 s5, s53, 6144
    buffer_load_dwordx4 v[60:63], v2, s[28:31], s5 offen sc1
    s_add_u32 s5, s53, 7168
    buffer_load_dwordx4 v[64:67], v2, s[28:31], s5 offen sc1
    s_waitcnt vmcnt(6)
    s_branch K2_PCHK3
K2_PGIVE3:
    s_mov_b32 s9, 1
    s_branch K2_PCONT3
K2_PRETRY4:
    s_sub_u32 s9, s9, 1
    s_cmp_eq_u32 s9, 0
    s_cbranch_scc1 K2_PGIVE4
    s_waitcnt vmcnt(0)

    s_add_u32 s5, s53, 2048
    buffer_load_dwordx4 v[44:47], v2, s[28:31], s5 offen sc1
    s_add_u32 s5, s53, 3072
    buffer_load_dwordx4 v[48:51], v2, s[28:31], s5 offen sc1
    s_add_u32 s5, s53, 4096
    buffer_load_dwordx4 v[52:55], v2, s[28:31], s5 offen sc1
    s_add_u32 s5, s53, 5120
    buffer_load_dwordx4 v[56:59], v2, s[28:31], s5 offen sc1
    s_add_u32 s5, s53, 6144
    buffer_load_dwordx4 v[60:63], v2, s[28:31], s5 offen sc1
    s_add_u32 s5, s53, 7168
    buffer_load_dwordx4 v[64:67], v2, s[28:31], s5 offen sc1
    s_waitcnt vmcnt(5)
    s_branch K2_PCHK4
K2_PGIVE4:
    s_mov_b32 s9, 1
    s_branch K2_PCONT4
K2_PRETRY5:
    s_sub_u32 s9, s9, 1
    s_cmp_eq_u32 s9, 0
    s_cbranch_scc1 K2_PGIVE5
    s_waitcnt vmcnt(0)

    s_add_u32 s5, s53, 3072
    buffer_load_dwordx4 v[48:51], v2, s[28:31], s5 offen sc1
    s_add_u32 s5, s53, 4096
    buffer_load_dwordx4 v[52:55], v2, s[28:31], s5 offen sc1
    s_add_u32 s5, s53, 5120
    buffer_load_dwordx4 v[56:59], v2, s[28:31], s5 offen sc1
    s_add_u32 s5, s53, 6144
    buffer_load_dwordx4 v[60:63], v2, s[28:31], s5 offen sc1
    s_add_u32 s5, s53, 7168
    buffer_load_dwordx4 v[64:67], v2, s[28:31], s5 offen sc1
    s_waitcnt vmcnt(4)
    s_branch K2_PCHK5
K2_PGIVE5:
    s_mov_b32 s9, 1
    s_branch K2_PCONT5
K2_PRETRY6:
    s_sub_u32 s9, s9, 1
    s_cmp_eq_u32 s9, 0
    s_cbranch_scc1 K2_PGIVE6
    s_waitcnt vmcnt(0)

    s_add_u32 s5, s53, 4096
    buffer_load_dwordx4 v[52:55], v2, s[28:31], s5 offen sc1
    s_add_u32 s5, s53, 5120
    buffer_load_dwordx4 v[56:59], v2, s[28:31], s5 offen sc1
    s_add_u32 s5, s53, 6144
    buffer_load_dwordx4 v[60:63], v2, s[28:31], s5 offen sc1
    s_add_u32 s5, s53, 7168
    buffer_load_dwordx4 v[64:67], v2, s[28:31], s5 offen sc1
    s_waitcnt vmcnt(3)
    s_branch K2_PCHK6
K2_PGIVE6:
    s_mov_b32 s9, 1
    s_branch K2_PCONT6
K2_PRETRY7:
    s_sub_u32 s9, s9, 1
    s_cmp_eq_u32 s9, 0
    s_cbranch_scc1 K2_PGIVE7
    s_waitcnt vmcnt(0)

    s_add_u32 s5, s53, 5120
    buffer_load_dwordx4 v[56:59], v2, s[28:31], s5 offen sc1
    s_add_u32 s5, s53, 6144
    buffer_load_dwordx4 v[60:63], v2, s[28:31], s5 offen sc1
    s_add_u32 s5, s53, 7168
    buffer_load_dwordx4 v[64:67], v2, s[28:31], s5 offen sc1
    s_waitcnt vmcnt(2)
    s_branch K2_PCHK7
K2_PGIVE7:
    s_mov_b32 s9, 1
    s_branch K2_PCONT7
K2_PRETRY8:
    s_sub_u32 s9, s9, 1
    s_cmp_eq_u32 s9, 0
    s_cbranch_scc1 K2_PGIVE8
    s_waitcnt vmcnt(0)

    s_add_u32 s5, s53, 6144
    buffer_load_dwordx4 v[60:63], v2, s[28:31], s5 offen sc1
    s_add_u32 s5, s53, 7168
    buffer_load_dwordx4 v[64:67], v2, s[28:31], s5 offen sc1
    s_waitcnt vmcnt(1)
    s_branch K2_PCHK8
K2_PGIVE8:
    s_mov_b32 s9, 1
    s_branch K2_PCONT8
K2_PRETRY9:
    s_sub_u32 s9, s9, 1
    s_cmp_eq_u32 s9, 0
    s_cbranch_scc1 K2_PGIVE9
    s_waitcnt vmcnt(0)

    s_add_u32 s5, s53, 7168
    buffer_load_dwordx4 v[64:67], v2, s[28:31], s5 offen sc1
    s_waitcnt vmcnt(0)
    s_branch K2_PCHK9
K2_PGIVE9:
    s_mov_b32 s9, 1
    s_branch K2_PCONT9
CODE_END:
.section .rodata,"a"
.p2align 6
.amdhsa_kernel qkv_kernel
  .amdhsa_next_free_vgpr 256
  .amdhsa_next_free_sgpr 64
  .amdhsa_accum_offset 160
  .amdhsa_group_segment_fixed_size 0
  .amdhsa_kernarg_size 80
  .amdhsa_user_sgpr_count 2
  .amdhsa_user_sgpr_kernarg_segment_ptr 1
  .amdhsa_system_sgpr_workgroup_id_x 1
.end_amdhsa_kernel
.p2align 6
.amdhsa_kernel attn_kernel
  .amdhsa_next_free_vgpr 128
  .amdhsa_next_free_sgpr 64
  .amdhsa_accum_offset 128
  .amdhsa_group_segment_fixed_size 0
  .amdhsa_kernarg_size 80
  .amdhsa_user_sgpr_count 2
  .amdhsa_user_sgpr_kernarg_segment_ptr 1
  .amdhsa_system_sgpr_workgroup_id_x 1
.end_amdhsa_kernel
```
